```python
import torch

def _softmax(x, axis=-1):
    return torch.softmax(x, dim=axis)
def _gelu(x):
    return torch.nn.functional.gelu(x, approximate="tanh")
def _silu(x):
    return torch.nn.functional.silu(x)
def _sigmoid(x):
    return torch.sigmoid(x)
def _layernorm(x, axis=-1, eps=1e-5):
    m = x.mean(dim=axis, keepdim=True)
    v = x.var(dim=axis, keepdim=True, unbiased=False)
    return (x - m) / torch.sqrt(v + eps)
def _scatter_add(tgt, idx, src, axis=0):
    return tgt.clone().index_add_(axis, idx, src)
def _segment_sum(src, seg, n):
    out = torch.zeros((n,) + src.shape[1:], dtype=src.dtype)
    return out.index_add_(0, seg, src)
def _pad(x, pw):
    flat = tuple(v for pair in reversed(pw) for v in pair)
    return torch.nn.functional.pad(x, flat)

kernel_name = 'gated_mix__sliding_block_cached__swiglu_ffn__decode'

def setup_inputs():

    _w = (lambda a: (lambda t: t.to(torch.bfloat16) if t.is_floating_point() else t)(torch.as_tensor(a)))
    def _A_setup():
        B, Sq, D = 2, 1, 512
        Hq, Hkv, Sk, Dh = 32, 8, 32768, 128
        assert Hq % Hkv == 0, (Hq, Hkv)
        return {
            "x": _w((lambda *s: torch.randn(*s, dtype=torch.bfloat16) * 0.05)(B, Sq, D)),
            "k_cache": _w((lambda *s: torch.randn(*s, dtype=torch.bfloat16) * 6.4)(B, Hkv, Sk, Dh)),
            "v_cache": _w((lambda *s: torch.randn(*s, dtype=torch.bfloat16) * 0.2)(B, Hkv, Sk, Dh)),
            "wq": _w((lambda *s: torch.randn(*s, dtype=torch.bfloat16) * 6.4)(D, Hq * Dh) * (D ** -0.5)),
            "wo": _w((lambda *s: torch.randn(*s, dtype=torch.bfloat16) * 0.2)(Hq * Dh, D) * ((Hq * Dh) ** -0.5)),
        }
    _A_in = _A_setup()

    def _B_setup():
        B, S, D, F = 2, 1, 512, 1792
        return {
            "x": _w((lambda *s: torch.randn(*s, dtype=torch.bfloat16) * 0.05)(B, S, D)),
            "w_gate": _w((lambda *s: torch.randn(*s, dtype=torch.bfloat16) * 0.05)(D, F)),
            "w_up": _w((lambda *s: torch.randn(*s, dtype=torch.bfloat16) * 0.05)(D, F)),
            "w_down": _w((lambda *s: torch.randn(*s, dtype=torch.bfloat16) * 0.05)(F, D)),
        }
    _B_in = _B_setup()

    return {
        "A_x": _A_in["x"],
        "A_k_cache": _A_in["k_cache"],
        "A_v_cache": _A_in["v_cache"],
        "A_wq": _A_in["wq"],
        "A_wo": _A_in["wo"],
        "B_x": _B_in["x"],
        "B_w_gate": _B_in["w_gate"],
        "B_w_up": _B_in["w_up"],
        "B_w_down": _B_in["w_down"],
        "gate_w": _w((lambda *s: torch.randn(*s, dtype=torch.bfloat16) * 0.05)(512) * 16.0),
    }

def reference(A_x, A_k_cache, A_v_cache, A_wq, A_wo, B_x, B_w_gate, B_w_up, B_w_down, gate_w):
    def _A_ref(x, k_cache, v_cache, wq, wo):
        B, Sq, D = x.shape
        Hq, Dh = 32, 128
        Hkv, Sk = k_cache.shape[1], k_cache.shape[2]
        W = min(4096, max(256, Sk // 4))
        rep = Hq // Hkv
        q = (lambda x, *d: x.permute(*d))((x @ wq).reshape(B, Sq, Hq, Dh), 0, 2, 1, 3)
        k = (lambda x, n, axis: torch.repeat_interleave(x, n, dim=axis))(k_cache[:, :, Sk - W:, :], rep, axis=1)
        v = (lambda x, n, axis: torch.repeat_interleave(x, n, dim=axis))(v_cache[:, :, Sk - W:, :], rep, axis=1)
        scores = torch.einsum("bhqd,bhkd->bhqk", q, k) * (Dh ** -0.5)
        p = _softmax(scores, axis=-1)
        o = torch.einsum("bhqk,bhkd->bhqd", p, v)
        return (lambda x, *d: x.permute(*d))(o, 0, 2, 1, 3).reshape(B, Sq, Hq * Dh) @ wo

    def _B_ref(x, w_gate, w_up, w_down):
        g = _silu(x @ w_gate)
        u = x @ w_up
        return (g * u) @ w_down

    x = A_x
    g = _sigmoid((x * gate_w).sum(-1, keepdims=True))
    a = _A_ref(x, A_k_cache, A_v_cache, A_wq, A_wo)
    b = _B_ref(x, B_w_gate, B_w_up, B_w_down)
    return g * a + (1 - g) * b
```

```asm
; @launch grid=(256,1,1) block=(768,1,1) lds=162560
.amdgcn_target "amdgcn-amd-amdhsa--gfx950"
.text
.globl gated_mix__sliding_block_cached__swiglu_ffn__decode_kernel
.p2align 8
.type gated_mix__sliding_block_cached__swiglu_ffn__decode_kernel,@function
gated_mix__sliding_block_cached__swiglu_ffn__decode_kernel:
    s_cmp_ge_u32 s2, 256
    s_cbranch_scc1 L_end
    v_lshrrev_b32 v1, 6, v0
    v_and_b32 v0, 63, v0
    s_and_b32 s31, s2, 7
    v_readfirstlane_b32 s30, v1
    s_nop 0
    s_cmp_lg_u32 s30, 2
    s_cbranch_scc1 L_noinit
    v_lshlrev_b32 v4, 2, v0
    v_add_u32 v4, 160272, v4
    v_mov_b32 v8, 0
    s_mov_b32 exec_lo, 0xffff
    s_mov_b32 exec_hi, 0
    ds_write_b32 v4, v8
    s_mov_b64 exec, -1
    s_waitcnt lgkmcnt(0)
L_noinit:
    s_load_dwordx16 s[4:19], s[0:1], 0
    s_load_dwordx8 s[20:27], s[0:1], 64
    s_load_dwordx2 s[28:29], s[0:1], 96
    s_barrier
    s_lshr_b32 s32, s2, 3
    s_lshr_b32 s33, s32, 4
    s_and_b32 s34, s32, 15
    s_mov_b32 s67, 400000
    v_and_b32 v2, 15, v0
    v_lshrrev_b32 v3, 4, v0
    s_lshr_b32 s52, s32, 3
    s_and_b32 s53, s32, 7
    s_lshl_b32 s54, s31, 2
    s_add_u32 s54, s54, s52
    s_lshl_b32 s50, s33, 3
    s_add_u32 s50, s50, s31
    s_lshl_b32 s50, s50, 23
    s_lshl_b32 s51, s34, 16
    s_add_u32 s50, s50, s51
    s_add_u32 s50, s50, 0x700000
    s_mul_i32 s51, s32, 5
    s_add_u32 s51, s51, s31
    s_and_b32 s49, s54, 7
    s_cmp_lg_u32 s49, 7
    s_cselect_b32 s49, 1, 0
    s_lshr_b32 s55, s54, 3
    s_sub_u32 s55, s54, s55
    s_cmp_lt_u32 s30, 4
    s_cbranch_scc1 L_special
    s_sub_u32 s35, s30, 4
    s_lshl_b32 s62, s35, 1
    s_add_u32 s62, s62, s51
    s_add_u32 s63, s62, 1
    s_and_b32 s62, s62, 15
    s_and_b32 s63, s63, 15
    s_lshl_b32 s62, s62, 12
    s_lshl_b32 s63, s63, 12
    s_add_u32 s61, s50, s63
    s_add_u32 s60, s50, s62
    v_add_u32 v104, 0, v3
    v_xor_b32 v104, v104, v2
    v_lshlrev_b32 v104, 4, v104
    v_lshl_add_u32 v104, v3, 8, v104
    v_add_u32 v105, 4, v3
    v_xor_b32 v105, v105, v2
    v_lshlrev_b32 v105, 4, v105
    v_lshl_add_u32 v105, v3, 8, v105
    v_add_u32 v106, 8, v3
    v_xor_b32 v106, v106, v2
    v_lshlrev_b32 v106, 4, v106
    v_lshl_add_u32 v106, v3, 8, v106
    v_add_u32 v107, 12, v3
    v_xor_b32 v107, v107, v2
    v_lshlrev_b32 v107, 4, v107
    v_lshl_add_u32 v107, v3, 8, v107
    s_lshl_b32 s84, s35, 13
    s_add_u32 s84, s84, 98304
    s_cmp_eq_u32 s35, 7
    s_cselect_b32 s84, 57344, s84
    s_add_u32 s85, s84, 4096
    v_bfe_u32 v114, v0, 1, 2
    v_bfe_u32 v115, v0, 4, 2
    v_xor_b32 v114, v114, v115
    v_and_b32 v115, 1, v0
    v_lshl_add_u32 v114, v114, 1, v115
    v_lshlrev_b32 v114, 4, v114
    v_lshrrev_b32 v115, 3, v0
    v_lshl_add_u32 v112, v115, 13, v114
    s_movk_i32 s62, 3584
    v_mul_lo_u32 v113, v115, s62
    v_add_u32 v113, v113, v114
    s_lshl_b32 s62, s52, 20
    s_lshl_b32 s63, s31, 10
    s_add_u32 s62, s62, s63
    s_lshl_b32 s63, s53, 7
    s_add_u32 s62, s62, s63
    s_lshl_b32 s63, s35, 18
    s_add_u32 s62, s62, s63
    s_lshl_b32 s86, s35, 12
    s_add_u32 s86, s86, 65536
    s_lshl_b32 s87, s53, 2
    s_add_u32 s87, s87, s35
    s_mul_i32 s87, s87, 16*3584
    s_lshl_b32 s71, s55, 7
    s_add_u32 s87, s87, s71
    s_lshl_b32 s71, s35, 11
    s_add_u32 s71, s71, 81920
    s_mov_b32 m0, s86
    s_cmp_lt_u32 s35, 4
    s_cselect_b32 s49, s49, 2
    s_waitcnt lgkmcnt(0)
    s_cmp_eq_u32 s49, 2
    s_cbranch_scc1 L_nogu
    s_cmp_gt_u32 s35, 1
    s_cbranch_scc1 L_nox
    s_mov_b32 s76, s4
    s_and_b32 s77, s5, 0xffff
    s_mov_b32 s78, 0x800
    s_mov_b32 s79, 0x20000
    s_lshl_b32 s63, s35, 10
    s_add_u32 m0, s63, 160512
    v_lshlrev_b32 v114, 4, v0
    buffer_load_dwordx4 v114, s[76:79], s63 offen lds
    s_mov_b32 m0, s86
L_nox:
    s_mov_b32 s40, s10
    s_and_b32 s41, s11, 0xffff
    s_mov_b32 s42, 0x400000
    s_mov_b32 s43, 0x20000
    buffer_load_dwordx4 v112, s[40:43], s62 offen nt lds
    s_add_u32 m0, s86, 1024
    s_add_u32 s62, s62, 65536
    buffer_load_dwordx4 v112, s[40:43], s62 offen nt lds
    s_add_u32 m0, s86, 2048
    s_add_u32 s62, s62, 65536
    buffer_load_dwordx4 v112, s[40:43], s62 offen nt lds
    s_add_u32 m0, s86, 3072
    s_add_u32 s62, s62, 65536
    buffer_load_dwordx4 v112, s[40:43], s62 offen nt lds
    s_cmp_eq_u32 s49, 0
    s_cbranch_scc1 L_nogu
    s_mov_b32 s76, s16
    s_and_b32 s77, s17, 0xffff
    s_mov_b32 s78, 0x1c0000
    s_mov_b32 s79, 0x20000
    s_mov_b32 m0, s71
    s_mov_b32 s92, s18
    s_and_b32 s93, s19, 0xffff
    s_mov_b32 s94, 0x1c0000
    s_mov_b32 s95, 0x20000
    buffer_load_dwordx4 v113, s[76:79], s87 offen nt lds
    s_add_u32 m0, s71, 8192
    s_nop 0
    buffer_load_dwordx4 v113, s[92:95], s87 offen nt lds
    s_add_u32 m0, s71, 1024
    s_add_u32 s87, s87, 28672
    buffer_load_dwordx4 v113, s[76:79], s87 offen nt lds
    s_add_u32 m0, s71, 9216
    s_nop 0
    buffer_load_dwordx4 v113, s[92:95], s87 offen nt lds
L_nogu:
    s_mov_b32 s86, s49
    s_mov_b32 s36, s6
    s_and_b32 s37, s7, 0xffff
    s_mov_b32 s38, 0x8000000
    s_mov_b32 s39, 0x20000
    s_mov_b32 s44, s28
    s_and_b32 s45, s29, 0xffff
    s_mov_b32 s46, 0x20000000
    s_mov_b32 s47, 0x20000
    s_add_u32 s80, s28, 0xe0000
    s_addc_u32 s81, s29, 0
    s_and_b32 s81, s81, 0xffff
    s_mov_b32 s82, 0x1ff20000
    s_mov_b32 s83, 0x20000
    s_mov_b32 s74, 0
    s_mov_b32 s56, 0x1f058840
    s_load_dwordx2 s[56:57], s[28:29], s56
    s_mov_b32 s68, 0x3db504f3
    s_mov_b32 s69, 0x3fb8aa3b
    s_mov_b32 s70, 0xbfb8aa3b
    s_mov_b32 s92, 0x0c0c0400
    s_mov_b32 s93, 0x04000c0c
    s_mov_b32 s94, 0x07060500
    s_mov_b32 s95, 0x07060501
    s_mov_b32 s96, 0x07060502
    s_mov_b32 s97, 0x07060503
    s_lshl_b32 s62, s31, 1
    s_add_u32 s62, s62, s33
    s_lshl_b32 s62, s62, 13
    s_lshl_b32 s63, s35, 8
    s_add_u32 s62, s62, s63
    s_add_u32 s62, s62, 0x1f000000
    v_lshlrev_b32 v6, 11, v3
    v_lshl_add_u32 v6, v2, 4, v6
    v_mov_b32 v12, 160272
    v_mov_b32 v13, 1
    v_add_u32 v108, 0, v3
    v_xor_b32 v108, v108, v2
    v_lshlrev_b32 v108, 4, v108
    v_lshl_add_u32 v108, v2, 8, v108
    v_add_u32 v108, s84, v108
    v_add_u32 v109, 4, v3
    v_xor_b32 v109, v109, v2
    v_lshlrev_b32 v109, 4, v109
    v_lshl_add_u32 v109, v2, 8, v109
    v_add_u32 v109, s84, v109
    v_add_u32 v110, 8, v3
    v_xor_b32 v110, v110, v2
    v_lshlrev_b32 v110, 4, v110
    v_lshl_add_u32 v110, v2, 8, v110
    v_add_u32 v110, s84, v110
    v_add_u32 v111, 12, v3
    v_xor_b32 v111, v111, v2
    v_lshlrev_b32 v111, 4, v111
    v_lshl_add_u32 v111, v2, 8, v111
    v_add_u32 v111, s84, v111
    s_cmp_lg_u32 s86, 2
    s_cbranch_scc1 L_old1
    s_mov_b32 m0, s84
    s_nop 0
    buffer_load_dwordx4 v104, s[36:39], s60 offen offset:0 nt lds
    buffer_load_dwordx4 v105, s[36:39], s60 offen offset:1024 nt lds
    buffer_load_dwordx4 v106, s[36:39], s60 offen offset:2048 nt lds
    buffer_load_dwordx4 v107, s[36:39], s60 offen offset:3072 nt lds
    s_mov_b32 m0, s85
    s_nop 0
    buffer_load_dwordx4 v104, s[36:39], s61 offen offset:0 nt lds
    buffer_load_dwordx4 v105, s[36:39], s61 offen offset:1024 nt lds
    buffer_load_dwordx4 v106, s[36:39], s61 offen offset:2048 nt lds
    buffer_load_dwordx4 v107, s[36:39], s61 offen offset:3072 nt lds
L_old1:
    v_and_b32 v14, 3, v2
    s_lshl_b32 s71, s35, 7
    s_add_u32 s71, s71, 157696
    v_lshl_add_u32 v10, v2, 3, s71
    v_lshl_add_u32 v10, v3, 1, v10
    v_lshlrev_b32 v11, 8, v14
    v_lshl_add_u32 v11, v3, 4, v11
    v_add_u32 v11, 157696, v11
    v_lshlrev_b32 v8, 5, v14
    v_add_u32 v8, 160000, v8
    s_lshl_b32 s71, s35, 2
    v_add_u32 v9, s71, v8
    v_lshl_add_u32 v7, v3, 2, v14
    v_lshlrev_b32 v7, 4, v7
    v_add_u32 v7, 155648, v7
    s_lshl_b32 s71, s35, 8
    v_add_u32 v5, s71, v7
    v_bfe_u32 v120, v0, 2, 3
    v_xor_b32 v120, s35, v120
    v_lshlrev_b32 v120, 5, v120
    v_and_b32 v121, 3, v0
    v_lshl_add_u32 v120, v121, 3, v120
    v_lshrrev_b32 v121, 2, v0
    v_lshl_add_u32 v120, v121, 8, v120
    v_lshlrev_b32 v121, 9, v14
    v_lshl_add_u32 v121, v3, 4, v121
    s_lshl_b32 s76, s31, 5
    s_add_u32 s49, s76, s32
    s_mul_i32 s49, s49, 2176
    s_add_u32 s49, s49, 0x1f058000
    s_lshl_b32 s71, s35, 6
    s_add_u32 s48, s49, s71
    v_lshrrev_b32 v122, 3, v2
    v_lshl_add_u32 v122, v122, 4, v3
    v_mul_u32_u24 v122, 2176, v122
    v_and_b32 v123, 7, v2
    v_lshl_add_u32 v122, v123, 4, v122
    s_mul_i32 s76, s76, 2176
    s_add_u32 s76, s76, 0x1f058000
    s_lshl_b32 s71, s52, 9
    s_add_u32 s76, s76, s71
    s_lshl_b32 s71, s35, 7
    s_add_u32 s76, s76, s71
    s_add_u32 s77, s76, 8704
    s_add_u32 s78, s76, 17408
    s_add_u32 s79, s76, 26112
    s_lshl_b32 s71, s35, 6
    s_add_u32 s71, s71, 158720
    v_lshrrev_b32 v124, 3, v2
    v_lshlrev_b32 v124, 8, v124
    v_lshl_add_u32 v124, v123, 3, v124
    v_lshl_add_u32 v124, v3, 1, v124
    v_add_u32 v124, s71, v124
    s_waitcnt lgkmcnt(0)
    s_add_u32 s58, s56, 0x01010101
    s_add_u32 s59, s57, 0x9e3779b9
    s_and_b32 s88, s58, 0xffff
    s_and_b32 s89, s58, 0xffff0000
    s_cmp_eq_u32 s86, 2
    s_cbranch_scc1 L_young
    s_cmp_eq_u32 s86, 0
    s_cbranch_scc1 L_nogu2
    s_waitcnt vmcnt(4)
    s_mov_b32 exec_lo, 0x1
    s_mov_b32 exec_hi, 0x0
    ds_add_u32 v12, v13 offset:52
    s_mov_b64 exec, -1
    s_waitcnt vmcnt(0)
    s_mov_b32 exec_lo, 0x1
    s_mov_b32 exec_hi, 0x0
    ds_add_u32 v12, v13 offset:56
    s_mov_b64 exec, -1
    s_branch L_gu3
L_nogu2:
    s_waitcnt vmcnt(0)
    s_mov_b32 exec_lo, 0x1
    s_mov_b32 exec_hi, 0x0
    ds_add_u32 v12, v13 offset:52
    s_mov_b64 exec, -1
L_gu3:
L_b1:
    ds_read_b32 v15, v12 offset:40
    s_waitcnt lgkmcnt(0)
    v_readfirstlane_b32 s66, v15
    s_sub_u32 s67, s67, 1
    s_cbranch_scc1 L_b1_x
    s_cmp_lt_u32 s66, 1
    s_cbranch_scc1 L_b1
L_b1_x:
    s_mov_b32 m0, s84
    s_nop 0
    buffer_load_dwordx4 v104, s[36:39], s60 offen offset:0 nt lds
    buffer_load_dwordx4 v105, s[36:39], s60 offen offset:1024 nt lds
    buffer_load_dwordx4 v106, s[36:39], s60 offen offset:2048 nt lds
    buffer_load_dwordx4 v107, s[36:39], s60 offen offset:3072 nt lds
    s_mov_b32 m0, s85
    s_nop 0
    buffer_load_dwordx4 v104, s[36:39], s61 offen offset:0 nt lds
    buffer_load_dwordx4 v105, s[36:39], s61 offen offset:1024 nt lds
    buffer_load_dwordx4 v106, s[36:39], s61 offen offset:2048 nt lds
    buffer_load_dwordx4 v107, s[36:39], s61 offen offset:3072 nt lds
L_young:
    s_mov_b32 exec_lo, 0x1
    s_mov_b32 exec_hi, 0x0
    ds_add_u32 v12, v13 offset:48
    s_mov_b64 exec, -1
L_b3:
    ds_read_b32 v15, v12 offset:48
    s_waitcnt lgkmcnt(0)
    v_readfirstlane_b32 s66, v15
    s_sub_u32 s67, s67, 1
    s_cbranch_scc1 L_b3_x
    s_cmp_lt_u32 s66, 8
    s_cbranch_scc1 L_b3
L_b3_x:
    buffer_load_dwordx4 v[80:83], v6, s[44:47], s62 offen sc1
    s_mov_b32 exec_lo, 0x1
    s_mov_b32 exec_hi, 0x0
    ds_add_u32 v12, v13 offset:44
    s_mov_b64 exec, -1
    s_setprio 3
L_d0:
    s_waitcnt vmcnt(5)
    ds_read_b128 v[16:19], v108 offset:0
    ds_read_b128 v[20:23], v109 offset:0
    ds_read_b128 v[24:27], v110 offset:0
    ds_read_b128 v[28:31], v111 offset:0
    s_waitcnt vmcnt(1)
    ds_read_b128 v[32:35], v108 offset:4096
    ds_read_b128 v[36:39], v109 offset:4096
    ds_read_b128 v[40:43], v110 offset:4096
    ds_read_b128 v[44:47], v111 offset:4096
    s_cmp_lg_u32 s35, 7
    s_cbranch_scc1 L_nok7
    s_waitcnt lgkmcnt(0)
    s_mov_b32 exec_lo, 0x1
    s_mov_b32 exec_hi, 0x0
    ds_add_u32 v12, v13 offset:20
    s_mov_b64 exec, -1
L_nok7:
    s_waitcnt vmcnt(0)
L_qchk:
    v_perm_b32 v89, v81, v80, s92
    v_perm_b32 v90, v83, v82, s93
    v_xor_b32 v89, s88, v89
    v_xor_b32 v90, s89, v90
    v_or_b32 v88, v89, v90
    s_nop 1
    v_or_b32_dpp v88, v88, v88 quad_perm:[1,0,3,2] row_mask:0xf bank_mask:0xf
    s_nop 1
    v_or_b32_dpp v88, v88, v88 quad_perm:[2,3,0,1] row_mask:0xf bank_mask:0xf
    v_cmp_ne_u32 vcc, 0, v88
    s_nop 1
    s_cbranch_vccz L_qchk_ok
    s_sub_u32 s67, s67, 1
    s_cbranch_scc1 L_qchk_ok
    s_mov_b64 exec, vcc
    s_add_u32 s74, s74, 1
    s_and_b32 s75, s74, 7
    s_cbranch_scc0 L_qchk_b
    buffer_load_dwordx4 v[80:83], v6, s[44:47], s62 offen sc1
    s_waitcnt vmcnt(0)
    s_branch L_qchk
L_qchk_b:
    buffer_load_dwordx4 v[80:83], v6, s[80:83], s62 offen sc1
    s_waitcnt vmcnt(0)
    s_branch L_qchk
L_qchk_ok:
    s_mov_b64 exec, -1
    v_and_b32 v80, 0xffffff00, v80
    v_and_b32 v81, 0xffffff00, v81
    v_and_b32 v82, 0xffffff00, v82
    v_and_b32 v83, 0xffffff00, v83
    s_nop 0
    v_permlane16_swap_b32 v80, v81
    v_permlane16_swap_b32 v82, v83
    s_nop 0
    v_add_f32 v80, v80, v81
    v_add_f32 v82, v82, v83
    s_nop 1
    v_permlane32_swap_b32 v80, v82
    s_nop 0
    v_add_f32 v80, v80, v82
    v_cvt_pk_bf16_f32 v80, v80, v80
    ds_write_b16 v10, v80
    s_mov_b32 exec_lo, 0x1
    s_mov_b32 exec_hi, 0x0
    ds_add_u32 v12, v13 offset:0
    s_mov_b64 exec, -1
L_qspin:
    ds_read_b32 v15, v12 offset:0
    s_waitcnt lgkmcnt(0)
    v_readfirstlane_b32 s66, v15
    s_sub_u32 s67, s67, 1
    s_cbranch_scc1 L_qspin_x
    s_cmp_lt_u32 s66, 8
    s_cbranch_scc1 L_qspin
L_qspin_x:
    ds_read_b128 v[80:83], v11 offset:0
    ds_read_b128 v[84:87], v11 offset:64
    ds_read_b128 v[88:91], v11 offset:128
    ds_read_b128 v[92:95], v11 offset:192
    s_waitcnt lgkmcnt(0)
    v_mfma_f32_16x16x32_bf16 v[96:99], v[16:19], v[80:83], 0
    v_mfma_f32_16x16x32_bf16 v[100:103], v[32:35], v[80:83], 0
    v_mfma_f32_16x16x32_bf16 v[96:99], v[20:23], v[84:87], v[96:99]
    v_mfma_f32_16x16x32_bf16 v[100:103], v[36:39], v[84:87], v[100:103]
    v_mfma_f32_16x16x32_bf16 v[96:99], v[24:27], v[88:91], v[96:99]
    v_mfma_f32_16x16x32_bf16 v[100:103], v[40:43], v[88:91], v[100:103]
    v_mfma_f32_16x16x32_bf16 v[96:99], v[28:31], v[92:95], v[96:99]
    v_mfma_f32_16x16x32_bf16 v[100:103], v[44:47], v[92:95], v[100:103]
    s_nop 7
    s_nop 1
    v_cvt_pk_bf16_f32 v112, v96, v97
    v_cvt_pk_bf16_f32 v113, v98, v99
    v_cvt_pk_bf16_f32 v114, v100, v101
    v_cvt_pk_bf16_f32 v115, v102, v103
    v_lshlrev_b32 v96, 16, v112
    v_and_b32 v97, 0xffff0000, v112
    v_lshlrev_b32 v98, 16, v113
    v_and_b32 v99, 0xffff0000, v113
    v_lshlrev_b32 v100, 16, v114
    v_and_b32 v101, 0xffff0000, v114
    v_lshlrev_b32 v102, 16, v115
    v_and_b32 v103, 0xffff0000, v115
    v_mul_f32 v96, s68, v96
    v_mul_f32 v97, s68, v97
    v_mul_f32 v98, s68, v98
    v_mul_f32 v99, s68, v99
    v_mul_f32 v100, s68, v100
    v_mul_f32 v101, s68, v101
    v_mul_f32 v102, s68, v102
    v_mul_f32 v103, s68, v103
    v_cvt_pk_bf16_f32 v112, v96, v97
    v_cvt_pk_bf16_f32 v113, v98, v99
    v_cvt_pk_bf16_f32 v114, v100, v101
    v_cvt_pk_bf16_f32 v115, v102, v103
    v_lshlrev_b32 v96, 16, v112
    v_and_b32 v97, 0xffff0000, v112
    v_lshlrev_b32 v98, 16, v113
    v_and_b32 v99, 0xffff0000, v113
    v_lshlrev_b32 v100, 16, v114
    v_and_b32 v101, 0xffff0000, v114
    v_lshlrev_b32 v102, 16, v115
    v_and_b32 v103, 0xffff0000, v115
    v_max3_f32 v116, v96, v97, v98
    v_max3_f32 v116, v116, v99, v100
    v_max3_f32 v116, v116, v101, v102
    v_max_f32 v116, v116, v103
    v_mov_b32 v117, v116
    s_nop 1
    v_permlane16_swap_b32 v116, v117
    s_nop 0
    v_max_f32 v116, v116, v117
    v_mov_b32 v117, v116
    s_nop 1
    v_permlane32_swap_b32 v116, v117
    s_nop 0
    v_max_f32 v116, v116, v117
    v_sub_f32 v96, v96, v116
    v_sub_f32 v97, v97, v116
    v_sub_f32 v98, v98, v116
    v_sub_f32 v99, v99, v116
    v_sub_f32 v100, v100, v116
    v_sub_f32 v101, v101, v116
    v_sub_f32 v102, v102, v116
    v_sub_f32 v103, v103, v116
    v_mul_f32 v96, s69, v96
    v_mul_f32 v97, s69, v97
    v_mul_f32 v98, s69, v98
    v_mul_f32 v99, s69, v99
    v_mul_f32 v100, s69, v100
    v_mul_f32 v101, s69, v101
    v_mul_f32 v102, s69, v102
    v_mul_f32 v103, s69, v103
    v_exp_f32 v96, v96
    v_exp_f32 v97, v97
    v_exp_f32 v98, v98
    v_exp_f32 v99, v99
    v_exp_f32 v100, v100
    v_exp_f32 v101, v101
    v_exp_f32 v102, v102
    v_exp_f32 v103, v103
    s_nop 0
    v_cvt_pk_bf16_f32 v112, v96, v97
    v_cvt_pk_bf16_f32 v113, v98, v99
    v_cvt_pk_bf16_f32 v114, v100, v101
    v_cvt_pk_bf16_f32 v115, v102, v103
    v_add_f32 v117, v96, v97
    v_add_f32 v118, v98, v99
    v_add_f32 v119, v100, v101
    v_add_f32 v104, v102, v103
    v_add_f32 v117, v117, v118
    v_add_f32 v119, v119, v104
    v_add_f32 v117, v117, v119
    s_mov_b32 exec_lo, 0xf000f
    s_mov_b32 exec_hi, 0xf000f
    ds_write_b128 v5, v[112:115]
    s_mov_b64 exec, -1
    v_mov_b32 v118, v117
    s_nop 1
    v_permlane16_swap_b32 v117, v118
    s_nop 0
    v_add_f32 v117, v117, v118
    v_mov_b32 v118, v117
    s_nop 1
    v_permlane32_swap_b32 v117, v118
    s_nop 0
    v_add_f32 v117, v117, v118
    s_mov_b32 exec_lo, 0xf
    s_mov_b32 exec_hi, 0x0
    ds_write2_b32 v9, v116, v117 offset0:0 offset1:32
    s_mov_b32 exec_lo, 0x1
    s_mov_b32 exec_hi, 0x0
    ds_add_u32 v12, v13 offset:8
    s_mov_b64 exec, -1
L_pspin1:
    ds_read_b32 v15, v12 offset:8
    s_waitcnt lgkmcnt(0)
    v_readfirstlane_b32 s66, v15
    s_sub_u32 s67, s67, 1
    s_cbranch_scc1 L_pspin1_x
    s_cmp_lt_u32 s66, 8
    s_cbranch_scc1 L_pspin1
L_pspin1_x:
    ds_read_b64 v[118:119], v12 offset:32
    ds_read_b128 v[104:107], v8
    ds_read_b128 v[108:111], v8 offset:16
    ds_read_b128 v[16:19], v7 offset:0
    ds_read_b128 v[20:23], v7 offset:256
    ds_read_b128 v[24:27], v7 offset:512
    ds_read_b128 v[28:31], v7 offset:768
    ds_read_b128 v[32:35], v7 offset:1024
    ds_read_b128 v[36:39], v7 offset:1280
    ds_read_b128 v[40:43], v7 offset:1536
    ds_read_b128 v[44:47], v7 offset:1792
    s_waitcnt lgkmcnt(0)
    v_min_u32 v118, v118, v119
    v_max3_f32 v116, v104, v105, v106
    v_max3_f32 v116, v116, v107, v108
    v_max3_f32 v116, v116, v109, v110
    v_max_f32 v116, v116, v111
    v_readfirstlane_b32 s71, v118
    v_sub_f32 v104, v104, v116
    v_sub_f32 v105, v105, v116
    v_sub_f32 v106, v106, v116
    v_sub_f32 v107, v107, v116
    v_sub_f32 v108, v108, v116
    v_sub_f32 v109, v109, v116
    v_sub_f32 v110, v110, v116
    v_sub_f32 v111, v111, v116
    v_mul_f32 v104, s69, v104
    v_mul_f32 v105, s69, v105
    v_mul_f32 v106, s69, v106
    v_mul_f32 v107, s69, v107
    v_mul_f32 v108, s69, v108
    v_mul_f32 v109, s69, v109
    v_mul_f32 v110, s69, v110
    v_mul_f32 v111, s69, v111
    v_exp_f32 v104, v104
    v_exp_f32 v105, v105
    v_exp_f32 v106, v106
    v_exp_f32 v107, v107
    v_exp_f32 v108, v108
    v_exp_f32 v109, v109
    v_exp_f32 v110, v110
    v_exp_f32 v111, v111
    v_or_b32 v125, s88, v116
    s_cmp_lg_u32 s35, 7
    s_cbranch_scc1 L_nol
    ds_read_b128 v[80:83], v8 offset:128
    ds_read_b128 v[84:87], v8 offset:144
    v_lshlrev_b32 v10, 4, v2
    v_mov_b32 v97, s58
    v_mov_b32 v98, v116
    v_mov_b32 v99, s59
    s_waitcnt lgkmcnt(0)
    v_mul_f32 v96, v104, v80
    v_fmac_f32 v96, v105, v81
    v_fmac_f32 v96, v106, v82
    v_fmac_f32 v96, v107, v83
    v_fmac_f32 v96, v108, v84
    v_fmac_f32 v96, v109, v85
    v_fmac_f32 v96, v110, v86
    v_fmac_f32 v96, v111, v87
    s_mov_b32 exec_lo, 0xf
    s_mov_b32 exec_hi, 0x0
    buffer_store_dwordx4 v[96:99], v10, s[44:47], s49 offen offset:2048
    buffer_store_dwordx4 v[96:99], v10, s[80:83], s49 offen offset:2048 sc1
    s_mov_b64 exec, -1
L_nol:
L_d1:
    s_cmp_lt_u32 s71, 7
    s_cbranch_scc1 L_vinc
    ds_read_b64_tr_b16 v[48:49], v120 offset:0
    ds_read_b64_tr_b16 v[50:51], v120 offset:4096
    ds_read_b64_tr_b16 v[52:53], v120 offset:8192
    ds_read_b64_tr_b16 v[54:55], v120 offset:12288
    ds_read_b64_tr_b16 v[56:57], v120 offset:16384
    ds_read_b64_tr_b16 v[58:59], v120 offset:20480
    ds_read_b64_tr_b16 v[60:61], v120 offset:24576
    ds_read_b64_tr_b16 v[62:63], v120 offset:28672
    ds_read_b64_tr_b16 v[64:65], v120 offset:32768
    ds_read_b64_tr_b16 v[66:67], v120 offset:36864
    ds_read_b64_tr_b16 v[68:69], v120 offset:40960
    ds_read_b64_tr_b16 v[70:71], v120 offset:45056
    ds_read_b64_tr_b16 v[72:73], v120 offset:49152
    ds_read_b64_tr_b16 v[74:75], v120 offset:53248
    s_waitcnt lgkmcnt(12)
    v_mfma_f32_16x16x32_bf16 v[128:131], v[48:51], v[16:19], 0
    s_waitcnt lgkmcnt(10)
    v_mfma_f32_16x16x32_bf16 v[132:135], v[52:55], v[20:23], 0
    s_waitcnt lgkmcnt(8)
    v_mfma_f32_16x16x32_bf16 v[136:139], v[56:59], v[24:27], 0
    s_waitcnt lgkmcnt(6)
    v_mfma_f32_16x16x32_bf16 v[140:143], v[60:63], v[28:31], 0
    s_waitcnt lgkmcnt(4)
    v_mfma_f32_16x16x32_bf16 v[144:147], v[64:67], v[32:35], 0
    s_waitcnt lgkmcnt(2)
    v_mfma_f32_16x16x32_bf16 v[148:151], v[68:71], v[36:39], 0
    s_waitcnt lgkmcnt(0)
    v_mfma_f32_16x16x32_bf16 v[152:155], v[72:75], v[40:43], 0
    s_branch L_vlast
L_vinc:
L_v1:
    ds_read_b64 v[14:15], v12 offset:32
    s_waitcnt lgkmcnt(0)
    v_min_u32 v15, v14, v15
    s_sub_u32 s67, s67, 1
    v_readfirstlane_b32 s66, v15
    s_cbranch_scc1 L_v1_x
    s_cmp_lt_u32 s66, 4
    s_cbranch_scc1 L_v1
L_v1_x:
    ds_read_b64_tr_b16 v[48:49], v120 offset:0
    ds_read_b64_tr_b16 v[50:51], v120 offset:4096
    ds_read_b64_tr_b16 v[52:53], v120 offset:8192
    ds_read_b64_tr_b16 v[54:55], v120 offset:12288
    ds_read_b64_tr_b16 v[56:57], v120 offset:16384
    ds_read_b64_tr_b16 v[58:59], v120 offset:20480
    ds_read_b64_tr_b16 v[60:61], v120 offset:24576
    ds_read_b64_tr_b16 v[62:63], v120 offset:28672
    s_waitcnt lgkmcnt(6)
    v_mfma_f32_16x16x32_bf16 v[128:131], v[48:51], v[16:19], 0
    s_waitcnt lgkmcnt(4)
    v_mfma_f32_16x16x32_bf16 v[132:135], v[52:55], v[20:23], 0
    s_waitcnt lgkmcnt(2)
    v_mfma_f32_16x16x32_bf16 v[136:139], v[56:59], v[24:27], 0
    s_waitcnt lgkmcnt(0)
    v_mfma_f32_16x16x32_bf16 v[140:143], v[60:63], v[28:31], 0
L_v2:
    ds_read_b64 v[14:15], v12 offset:32
    s_waitcnt lgkmcnt(0)
    v_min_u32 v15, v14, v15
    s_sub_u32 s67, s67, 1
    v_readfirstlane_b32 s66, v15
    s_cbranch_scc1 L_v2_x
    s_cmp_lt_u32 s66, 6
    s_cbranch_scc1 L_v2
L_v2_x:
    ds_read_b64_tr_b16 v[64:65], v120 offset:32768
    ds_read_b64_tr_b16 v[66:67], v120 offset:36864
    ds_read_b64_tr_b16 v[68:69], v120 offset:40960
    ds_read_b64_tr_b16 v[70:71], v120 offset:45056
    s_waitcnt lgkmcnt(2)
    v_mfma_f32_16x16x32_bf16 v[144:147], v[64:67], v[32:35], 0
    s_waitcnt lgkmcnt(0)
    v_mfma_f32_16x16x32_bf16 v[148:151], v[68:71], v[36:39], 0
L_v3:
    ds_read_b64 v[14:15], v12 offset:32
    s_waitcnt lgkmcnt(0)
    v_min_u32 v15, v14, v15
    s_sub_u32 s67, s67, 1
    v_readfirstlane_b32 s66, v15
    s_cbranch_scc1 L_v3_x
    s_cmp_lt_u32 s66, 7
    s_cbranch_scc1 L_v3
L_v3_x:
    ds_read_b64_tr_b16 v[72:73], v120 offset:49152
    ds_read_b64_tr_b16 v[74:75], v120 offset:53248
    s_waitcnt lgkmcnt(0)
    v_mfma_f32_16x16x32_bf16 v[152:155], v[72:75], v[40:43], 0
L_vlast:
    s_nop 3
    v_mul_f32 v80, v104, v128
    v_mul_f32 v81, v104, v129
    v_mul_f32 v82, v104, v130
    v_mul_f32 v83, v104, v131
    v_fmac_f32 v80, v105, v132
    v_fmac_f32 v81, v105, v133
    v_fmac_f32 v82, v105, v134
    v_fmac_f32 v83, v105, v135
    v_fmac_f32 v80, v106, v136
    v_fmac_f32 v81, v106, v137
    v_fmac_f32 v82, v106, v138
    v_fmac_f32 v83, v106, v139
    v_fmac_f32 v80, v107, v140
    v_fmac_f32 v81, v107, v141
    v_fmac_f32 v82, v107, v142
    v_fmac_f32 v83, v107, v143
    v_fmac_f32 v80, v108, v144
    v_fmac_f32 v81, v108, v145
    v_fmac_f32 v82, v108, v146
    v_fmac_f32 v83, v108, v147
    v_fmac_f32 v80, v109, v148
    v_fmac_f32 v81, v109, v149
    v_fmac_f32 v82, v109, v150
    v_fmac_f32 v83, v109, v151
    v_fmac_f32 v80, v110, v152
    v_fmac_f32 v81, v110, v153
    v_fmac_f32 v82, v110, v154
    v_fmac_f32 v83, v110, v155
    s_barrier
    ds_read_b64_tr_b16 v[76:77], v120 offset:57344
    ds_read_b64_tr_b16 v[78:79], v120 offset:61440
    s_waitcnt lgkmcnt(0)
    v_mfma_f32_16x16x32_bf16 v[156:159], v[76:79], v[44:47], 0
    s_mov_b32 exec_lo, 0xf000f
    s_mov_b32 exec_hi, 0xf000f
    s_nop 5
    v_fmac_f32 v80, v111, v156
    v_fmac_f32 v81, v111, v157
    v_fmac_f32 v82, v111, v158
    v_fmac_f32 v83, v111, v159
    v_perm_b32 v84, v80, v125, s94
    v_perm_b32 v85, v81, v125, s95
    v_perm_b32 v86, v82, v125, s96
    v_perm_b32 v87, v83, v125, s97
    buffer_store_dwordx4 v[84:87], v121, s[44:47], s48 offen
    buffer_store_dwordx4 v[84:87], v121, s[80:83], s48 offen sc1
    s_mov_b64 exec, -1
    s_barrier
    s_cmp_ge_u32 s35, 4
    s_cbranch_scc1 L_kv_h2
    buffer_load_dwordx4 v[80:83], v122, s[44:47], s76 offen sc1
    buffer_load_dwordx4 v[84:87], v122, s[44:47], s77 offen sc1
    buffer_load_dwordx4 v[88:91], v122, s[44:47], s78 offen sc1
    buffer_load_dwordx4 v[92:95], v122, s[44:47], s79 offen sc1
    s_waitcnt vmcnt(0)
L_h1chk:
    v_perm_b32 v117, v81, v80, s92
    v_xor_b32 v117, s88, v117
    v_perm_b32 v118, v85, v84, s92
    v_xor_b32 v118, s88, v118
    v_or_b32 v116, v117, v118
    v_perm_b32 v117, v89, v88, s92
    v_xor_b32 v117, s88, v117
    v_perm_b32 v118, v93, v92, s92
    v_xor_b32 v118, s88, v118
    v_or3_b32 v116, v116, v117, v118
    s_nop 1
    v_or_b32_dpp v116, v116, v116 quad_perm:[1,0,3,2] row_mask:0xf bank_mask:0xf
    s_nop 1
    v_or_b32_dpp v116, v116, v116 quad_perm:[2,3,0,1] row_mask:0xf bank_mask:0xf
    s_nop 1
    v_or_b32_dpp v116, v116, v116 row_half_mirror row_mask:0xf bank_mask:0xf
    v_cmp_ne_u32 vcc, 0, v116
    s_nop 1
    s_cbranch_vccz L_h1chk_ok
    s_sub_u32 s67, s67, 1
    s_cbranch_scc1 L_h1chk_ok
    s_mov_b64 exec, vcc
    s_add_u32 s74, s74, 1
    s_and_b32 s75, s74, 7
    s_cbranch_scc0 L_h1chk_b
    buffer_load_dwordx4 v[80:83], v122, s[44:47], s76 offen sc1
    buffer_load_dwordx4 v[84:87], v122, s[44:47], s77 offen sc1
    buffer_load_dwordx4 v[88:91], v122, s[44:47], s78 offen sc1
    buffer_load_dwordx4 v[92:95], v122, s[44:47], s79 offen sc1
    s_waitcnt vmcnt(0)
    s_branch L_h1chk
L_h1chk_b:
    buffer_load_dwordx4 v[80:83], v122, s[80:83], s76 offen sc1
    buffer_load_dwordx4 v[84:87], v122, s[80:83], s77 offen sc1
    buffer_load_dwordx4 v[88:91], v122, s[80:83], s78 offen sc1
    buffer_load_dwordx4 v[92:95], v122, s[80:83], s79 offen sc1
    s_waitcnt vmcnt(0)
    s_branch L_h1chk
L_h1chk_ok:
    s_mov_b64 exec, -1
    v_perm_b32 v100, v83, v82, s93
    v_perm_b32 v101, v87, v86, s93
    v_perm_b32 v102, v91, v90, s93
    v_perm_b32 v103, v95, v94, s93
    v_max3_f32 v116, v100, v101, v102
    v_max_f32 v116, v116, v103
    v_mov_b32 v117, v116
    s_nop 1
    v_permlane16_swap_b32 v116, v117
    s_nop 0
    v_max_f32 v116, v116, v117
    v_mov_b32 v117, v116
    s_nop 1
    v_permlane32_swap_b32 v116, v117
    s_nop 0
    v_max_f32 v116, v116, v117
    v_sub_f32 v100, v100, v116
    v_sub_f32 v101, v101, v116
    v_sub_f32 v102, v102, v116
    v_sub_f32 v103, v103, v116
    v_mul_f32 v100, s69, v100
    v_mul_f32 v101, s69, v101
    v_mul_f32 v102, s69, v102
    v_mul_f32 v103, s69, v103
    v_exp_f32 v100, v100
    v_exp_f32 v101, v101
    v_exp_f32 v102, v102
    v_exp_f32 v103, v103
    v_and_b32 v80, 0xffffff00, v80
    v_and_b32 v81, 0xffffff00, v81
    v_and_b32 v82, 0xffffff00, v82
    v_and_b32 v83, 0xffffff00, v83
    v_and_b32 v84, 0xffffff00, v84
    v_and_b32 v85, 0xffffff00, v85
    v_and_b32 v86, 0xffffff00, v86
    v_and_b32 v87, 0xffffff00, v87
    v_and_b32 v88, 0xffffff00, v88
    v_and_b32 v89, 0xffffff00, v89
    v_and_b32 v90, 0xffffff00, v90
    v_and_b32 v91, 0xffffff00, v91
    v_and_b32 v92, 0xffffff00, v92
    v_and_b32 v93, 0xffffff00, v93
    v_and_b32 v94, 0xffffff00, v94
    v_and_b32 v95, 0xffffff00, v95
    v_mul_f32 v104, v100, v80
    v_mul_f32 v105, v100, v81
    v_mul_f32 v106, v100, v82
    v_mul_f32 v107, v100, v83
    v_fmac_f32 v104, v101, v84
    v_fmac_f32 v105, v101, v85
    v_fmac_f32 v106, v101, v86
    v_fmac_f32 v107, v101, v87
    v_fmac_f32 v104, v102, v88
    v_fmac_f32 v105, v102, v89
    v_fmac_f32 v106, v102, v90
    v_fmac_f32 v107, v102, v91
    v_fmac_f32 v104, v103, v92
    v_fmac_f32 v105, v103, v93
    v_fmac_f32 v106, v103, v94
    v_fmac_f32 v107, v103, v95
    s_nop 0
    v_permlane16_swap_b32 v104, v105
    v_permlane16_swap_b32 v106, v107
    s_nop 0
    v_add_f32 v104, v104, v105
    v_add_f32 v106, v106, v107
    s_nop 1
    v_permlane32_swap_b32 v104, v106
    s_nop 0
    v_add_f32 v104, v104, v106
    v_cvt_pk_bf16_f32 v104, v104, v104
    ds_write_b16 v124, v104
    s_waitcnt lgkmcnt(0)
    s_barrier
    s_branch L_kv_done
L_kv_h2:
    s_cmp_lg_u32 s35, 7
    s_cbranch_scc1 L_kv_bo
    s_cmp_ge_u32 s2, 128
    s_cbranch_scc1 L_kv_bo
L_d2:
    s_mov_b32 s48, s24
    s_and_b32 s49, s25, 0xffff
    s_mov_b32 s50, 0x800
    s_mov_b32 s51, 0x20000
    s_lshl_b32 s3, s31, 4
    s_or_b32 s3, s3, s32
    s_lshl_b32 s60, s3, 11
    s_add_u32 s60, s60, 0x1f0e0000
    v_lshlrev_b32 v5, 4, v0
    v_mov_b32 v8, 0
    v_lshrrev_b32 v11, 5, v0
    v_lshlrev_b32 v11, 10, v11
    s_lshl_b32 s62, s3, 3
    buffer_load_dword v9, v8, s[48:51], s62 offen
    buffer_load_dword v10, v8, s[48:51], s62 offen offset:1024
    s_barrier
    buffer_load_dwordx4 v[16:19], v5, s[80:83], s60 offen sc1
    buffer_load_dwordx4 v[20:23], v5, s[80:83], s60 offen offset:1024 sc1
    s_waitcnt vmcnt(0)
L_h2chk:
    v_xor_b32 v25, s58, v17
    v_xor_b32 v26, s59, v19
    v_or_b32 v24, v25, v26
    v_xor_b32 v25, s58, v21
    v_xor_b32 v26, s59, v23
    v_or3_b32 v24, v24, v25, v26
    v_cmp_ne_u32 vcc, 0, v24
    s_nop 1
    s_cbranch_vccz L_h2chk_ok
    s_sub_u32 s67, s67, 1
    s_cbranch_scc1 L_h2chk_ok
    s_mov_b64 exec, vcc
    buffer_load_dwordx4 v[16:19], v5, s[80:83], s60 offen sc1
    buffer_load_dwordx4 v[20:23], v5, s[80:83], s60 offen offset:1024 sc1
    s_waitcnt vmcnt(0)
    s_branch L_h2chk
L_h2chk_ok:
    s_mov_b64 exec, -1
    v_add_f32 v16, v16, v20
    v_add_f32 v18, v18, v22
    s_nop 1
    v_permlane32_swap_b32 v16, v18
    s_nop 0
    v_add_f32 v16, v16, v18
    v_mov_b32 v17, v16
    s_nop 1
    v_permlane16_swap_b32 v16, v17
    s_nop 0
    v_add_f32 v16, v16, v17
    s_nop 1
    v_add_f32_dpp v16, v16, v16 row_ror:8 row_mask:0xf bank_mask:0xf
    s_nop 1
    v_add_f32_dpp v16, v16, v16 row_ror:4 row_mask:0xf bank_mask:0xf
    s_nop 1
    v_mov_b32_dpp v24, v16 quad_perm:[1,1,1,1] row_mask:0xf bank_mask:0xf
    v_mov_b32_dpp v25, v16 quad_perm:[2,2,2,2] row_mask:0xf bank_mask:0xf
    v_mov_b32_dpp v26, v16 quad_perm:[3,3,3,3] row_mask:0xf bank_mask:0xf
    v_cvt_pk_bf16_f32 v32, v16, v24
    v_cvt_pk_bf16_f32 v33, v25, v26
    s_mov_b32 exec_lo, 0x1
    s_mov_b32 exec_hi, 0x1
    buffer_store_dwordx2 v[32:33], v11, s[48:51], s62 offen
    s_mov_b32 exec_hi, 0
    s_cmp_lg_u32 s2, 0
    s_cbranch_scc1 L_kv_done
    v_mov_b32 v36, s58
    v_mov_b32 v37, s59
    s_mov_b32 s62, 0x1f058840
    buffer_store_dwordx2 v[36:37], v8, s[44:47], s62 offen sc1
    s_branch L_kv_done
L_kv_bo:
    s_barrier
L_kv_done:
    s_endpgm
L_special:
    v_and_b32 v6, 1, v2
    v_lshlrev_b32 v6, 10, v6
    v_lshl_add_u32 v6, v3, 3, v6
    s_cmp_eq_u32 s30, 0
    s_cbranch_scc1 L_w0
    s_cmp_eq_u32 s30, 1
    s_cbranch_scc1 L_w1
    s_cmp_eq_u32 s30, 3
    s_cbranch_scc1 L_w3
    s_waitcnt lgkmcnt(0)
    s_mov_b32 s44, s28
    s_and_b32 s45, s29, 0xffff
    s_mov_b32 s46, 0x20000000
    s_mov_b32 s47, 0x20000
    s_add_u32 s80, s28, 0xe0000
    s_addc_u32 s81, s29, 0
    s_and_b32 s81, s81, 0xffff
    s_mov_b32 s82, 0x1ff20000
    s_mov_b32 s83, 0x20000
    s_mov_b32 s74, 0
    s_mov_b32 s56, 0x1f058840
    s_load_dwordx2 s[56:57], s[28:29], s56
L_w2ret:
    s_mov_b64 exec, -1
    s_mov_b32 s68, 0x3db504f3
    s_mov_b32 s69, 0x3fb8aa3b
    s_mov_b32 s70, 0xbfb8aa3b
    s_mov_b32 s92, 0x0c0c0400
    s_mov_b32 s93, 0x04000c0c
    s_mov_b32 s94, 0x07060500
    s_mov_b32 s95, 0x07060501
    s_mov_b32 s96, 0x07060502
    s_mov_b32 s97, 0x07060503
    s_waitcnt lgkmcnt(0)
    s_add_u32 s58, s56, 0x01010101
    s_add_u32 s59, s57, 0x9e3779b9
    s_and_b32 s88, s58, 0xffff
    s_and_b32 s89, s58, 0xffff0000
    s_branch L_vload
L_w3:
    v_lshlrev_b32 v5, 4, v0
    s_waitcnt lgkmcnt(0)
    s_mov_b32 s36, s4
    s_and_b32 s37, s5, 0xffff
    s_mov_b32 s38, 0x800
    s_mov_b32 s39, 0x20000
    s_mov_b32 s40, s22
    s_and_b32 s41, s23, 0xffff
    s_mov_b32 s42, 0x400
    s_mov_b32 s43, 0x20000
    buffer_load_dwordx4 v[16:19], v5, s[36:39], 0 offen
    buffer_load_dwordx4 v[20:23], v5, s[36:39], 0 offen offset:1024
    buffer_load_dwordx4 v[24:27], v5, s[40:43], 0 offen
    s_mov_b32 s44, s28
    s_and_b32 s45, s29, 0xffff
    s_mov_b32 s46, 0x20000000
    s_mov_b32 s47, 0x20000
    s_add_u32 s80, s28, 0xe0000
    s_addc_u32 s81, s29, 0
    s_and_b32 s81, s81, 0xffff
    s_mov_b32 s82, 0x1ff20000
    s_mov_b32 s83, 0x20000
    s_mov_b32 s74, 0
    s_mov_b32 s56, 0x1f058840
    s_load_dwordx2 s[56:57], s[28:29], s56
    s_mov_b32 s68, 0x3db504f3
    s_mov_b32 s69, 0x3fb8aa3b
    s_mov_b32 s70, 0xbfb8aa3b
    s_mov_b32 s92, 0x0c0c0400
    s_mov_b32 s93, 0x04000c0c
    s_mov_b32 s94, 0x07060500
    s_mov_b32 s95, 0x07060501
    s_mov_b32 s96, 0x07060502
    s_mov_b32 s97, 0x07060503
    s_waitcnt vmcnt(0)
    v_lshlrev_b32 v32, 16, v24
    v_and_b32 v33, 0xffff0000, v24
    v_lshlrev_b32 v34, 16, v25
    v_and_b32 v35, 0xffff0000, v25
    v_lshlrev_b32 v36, 16, v26
    v_and_b32 v37, 0xffff0000, v26
    v_lshlrev_b32 v38, 16, v27
    v_and_b32 v39, 0xffff0000, v27
    v_lshlrev_b32 v40, 16, v16
    v_and_b32 v41, 0xffff0000, v16
    v_lshlrev_b32 v42, 16, v17
    v_and_b32 v43, 0xffff0000, v17
    v_lshlrev_b32 v44, 16, v18
    v_and_b32 v45, 0xffff0000, v18
    v_lshlrev_b32 v46, 16, v19
    v_and_b32 v47, 0xffff0000, v19
    v_lshlrev_b32 v48, 16, v20
    v_and_b32 v49, 0xffff0000, v20
    v_lshlrev_b32 v50, 16, v21
    v_and_b32 v51, 0xffff0000, v21
    v_lshlrev_b32 v52, 16, v22
    v_and_b32 v53, 0xffff0000, v22
    v_lshlrev_b32 v54, 16, v23
    v_and_b32 v55, 0xffff0000, v23
    v_mul_f32 v40, v40, v32
    v_mul_f32 v41, v41, v33
    v_mul_f32 v42, v42, v34
    v_mul_f32 v43, v43, v35
    v_mul_f32 v44, v44, v36
    v_mul_f32 v45, v45, v37
    v_mul_f32 v46, v46, v38
    v_mul_f32 v47, v47, v39
    v_mul_f32 v48, v48, v32
    v_mul_f32 v49, v49, v33
    v_mul_f32 v50, v50, v34
    v_mul_f32 v51, v51, v35
    v_mul_f32 v52, v52, v36
    v_mul_f32 v53, v53, v37
    v_mul_f32 v54, v54, v38
    v_mul_f32 v55, v55, v39
    v_cvt_pk_bf16_f32 v16, v40, v41
    v_cvt_pk_bf16_f32 v17, v42, v43
    v_cvt_pk_bf16_f32 v18, v44, v45
    v_cvt_pk_bf16_f32 v19, v46, v47
    v_cvt_pk_bf16_f32 v20, v48, v49
    v_cvt_pk_bf16_f32 v21, v50, v51
    v_cvt_pk_bf16_f32 v22, v52, v53
    v_cvt_pk_bf16_f32 v23, v54, v55
    v_lshlrev_b32 v40, 16, v16
    v_and_b32 v41, 0xffff0000, v16
    v_lshlrev_b32 v42, 16, v17
    v_and_b32 v43, 0xffff0000, v17
    v_lshlrev_b32 v44, 16, v18
    v_and_b32 v45, 0xffff0000, v18
    v_lshlrev_b32 v46, 16, v19
    v_and_b32 v47, 0xffff0000, v19
    v_lshlrev_b32 v48, 16, v20
    v_and_b32 v49, 0xffff0000, v20
    v_lshlrev_b32 v50, 16, v21
    v_and_b32 v51, 0xffff0000, v21
    v_lshlrev_b32 v52, 16, v22
    v_and_b32 v53, 0xffff0000, v22
    v_lshlrev_b32 v54, 16, v23
    v_and_b32 v55, 0xffff0000, v23
    v_add_f32 v40, v40, v41
    v_add_f32 v42, v42, v43
    v_add_f32 v44, v44, v45
    v_add_f32 v46, v46, v47
    v_add_f32 v40, v40, v42
    v_add_f32 v44, v44, v46
    v_add_f32 v40, v40, v44
    v_add_f32 v48, v48, v49
    v_add_f32 v50, v50, v51
    v_add_f32 v52, v52, v53
    v_add_f32 v54, v54, v55
    v_add_f32 v48, v48, v50
    v_add_f32 v52, v52, v54
    v_add_f32 v48, v48, v52
    s_nop 1
    v_add_f32_dpp v40, v40, v40 row_ror:8 row_mask:0xf bank_mask:0xf
    v_add_f32_dpp v48, v48, v48 row_ror:8 row_mask:0xf bank_mask:0xf
    s_nop 1
    v_add_f32_dpp v40, v40, v40 row_ror:4 row_mask:0xf bank_mask:0xf
    v_add_f32_dpp v48, v48, v48 row_ror:4 row_mask:0xf bank_mask:0xf
    s_nop 1
    v_add_f32_dpp v40, v40, v40 row_ror:2 row_mask:0xf bank_mask:0xf
    v_add_f32_dpp v48, v48, v48 row_ror:2 row_mask:0xf bank_mask:0xf
    s_nop 1
    v_add_f32_dpp v40, v40, v40 row_ror:1 row_mask:0xf bank_mask:0xf
    v_add_f32_dpp v48, v48, v48 row_ror:1 row_mask:0xf bank_mask:0xf
    v_mov_b32 v41, v40
    v_mov_b32 v49, v48
    s_nop 0
    v_permlane16_swap_b32 v40, v41
    v_permlane16_swap_b32 v48, v49
    s_nop 0
    v_add_f32 v40, v40, v41
    v_add_f32 v48, v48, v49
    v_mov_b32 v41, v40
    v_mov_b32 v49, v48
    s_nop 0
    v_permlane32_swap_b32 v40, v41
    v_permlane32_swap_b32 v48, v49
    s_nop 0
    v_add_f32 v40, v40, v41
    v_add_f32 v48, v48, v49
    v_mov_b32 v41, v48
    v_cvt_pk_bf16_f32 v16, v40, v41
    v_lshlrev_b32 v40, 16, v16
    v_and_b32 v41, 0xffff0000, v16
    v_mul_f32 v40, s70, v40
    v_mul_f32 v41, s70, v41
    v_exp_f32 v40, v40
    v_exp_f32 v41, v41
    s_nop 0
    v_add_f32 v40, 1.0, v40
    v_add_f32 v41, 1.0, v41
    v_rcp_f32 v40, v40
    v_rcp_f32 v41, v41
    s_nop 0
    v_cvt_pk_bf16_f32 v16, v40, v41
    v_lshlrev_b32 v40, 16, v16
    v_and_b32 v41, 0xffff0000, v16
    v_sub_f32 v42, 1.0, v40
    v_sub_f32 v43, 1.0, v41
    v_cvt_pk_bf16_f32 v16, v42, v43
    v_lshlrev_b32 v42, 16, v16
    v_and_b32 v43, 0xffff0000, v16
    v_mov_b32 v4, 160256
    ds_write_b128 v4, v[40:43]
    s_waitcnt lgkmcnt(0)
    s_add_u32 s58, s56, 0x01010101
    s_add_u32 s59, s57, 0x9e3779b9
    s_and_b32 s88, s58, 0xffff
    s_and_b32 s89, s58, 0xffff0000
L_vload:
    s_mov_b32 s40, s8
    s_and_b32 s41, s9, 0xffff
    s_mov_b32 s42, 0x8000000
    s_mov_b32 s43, 0x20000
    s_sub_u32 s35, s30, 2
    s_lshl_b32 s60, s35, 2
    v_add_u32 v4, s60, v3
    v_lshrrev_b32 v5, 1, v2
    v_xor_b32 v4, v4, v5
    v_and_b32 v5, 1, v2
    v_lshl_add_u32 v4, v4, 1, v5
    v_lshlrev_b32 v4, 4, v4
    v_lshl_add_u32 v4, v3, 8, v4
    s_lshl_b32 s61, s35, 10
    s_add_u32 s62, s50, s61
    s_and_b32 s60, s51, 15
    s_lshl_b32 s60, s60, 12
    v_mov_b32 v12, 160272
    v_mov_b32 v13, 1
    s_lshl_b32 s63, s35, 2
    s_add_u32 s63, s63, 160304
    v_mov_b32 v11, s63
    v_mov_b32 v8, 4
    v_mov_b32 v9, 6
    v_mov_b32 v10, 8
    v_mov_b32 v7, 7
L_b2:
    ds_read_b32 v15, v12 offset:44
    s_waitcnt lgkmcnt(0)
    v_readfirstlane_b32 s66, v15
    s_sub_u32 s67, s67, 1
    s_cbranch_scc1 L_b2_x
    s_cmp_lt_u32 s66, 8
    s_cbranch_scc1 L_b2
L_b2_x:
    s_add_u32 s63, s62, s60
    s_add_u32 m0, s61, 0
    s_add_u32 s60, s60, 4096
    s_and_b32 s60, s60, 0xffff
    buffer_load_dwordx4 v4, s[40:43], s63 offen nt lds
    buffer_load_dwordx4 v4, s[40:43], s63 offen offset:2048 nt lds
    s_add_u32 s63, s62, s60
    s_add_u32 m0, s61, 4096
    s_add_u32 s60, s60, 4096
    s_and_b32 s60, s60, 0xffff
    buffer_load_dwordx4 v4, s[40:43], s63 offen nt lds
    buffer_load_dwordx4 v4, s[40:43], s63 offen offset:2048 nt lds
    s_add_u32 s63, s62, s60
    s_add_u32 m0, s61, 8192
    s_add_u32 s60, s60, 4096
    s_and_b32 s60, s60, 0xffff
    buffer_load_dwordx4 v4, s[40:43], s63 offen nt lds
    buffer_load_dwordx4 v4, s[40:43], s63 offen offset:2048 nt lds
    s_add_u32 s63, s62, s60
    s_add_u32 m0, s61, 12288
    s_add_u32 s60, s60, 4096
    s_and_b32 s60, s60, 0xffff
    buffer_load_dwordx4 v4, s[40:43], s63 offen nt lds
    buffer_load_dwordx4 v4, s[40:43], s63 offen offset:2048 nt lds
    s_add_u32 s63, s62, s60
    s_add_u32 m0, s61, 16384
    s_add_u32 s60, s60, 4096
    s_and_b32 s60, s60, 0xffff
    buffer_load_dwordx4 v4, s[40:43], s63 offen nt lds
    buffer_load_dwordx4 v4, s[40:43], s63 offen offset:2048 nt lds
    s_add_u32 s63, s62, s60
    s_add_u32 m0, s61, 20480
    s_add_u32 s60, s60, 4096
    s_and_b32 s60, s60, 0xffff
    buffer_load_dwordx4 v4, s[40:43], s63 offen nt lds
    buffer_load_dwordx4 v4, s[40:43], s63 offen offset:2048 nt lds
    s_mov_b32 exec_lo, 1
    s_mov_b32 exec_hi, 0
    ds_add_u32 v12, v13 offset:24
    s_mov_b64 exec, -1
    s_add_u32 s63, s62, s60
    s_add_u32 m0, s61, 24576
    s_add_u32 s60, s60, 4096
    s_and_b32 s60, s60, 0xffff
    buffer_load_dwordx4 v4, s[40:43], s63 offen nt lds
    buffer_load_dwordx4 v4, s[40:43], s63 offen offset:2048 nt lds
    s_add_u32 s63, s62, s60
    s_add_u32 m0, s61, 28672
    s_add_u32 s60, s60, 4096
    s_and_b32 s60, s60, 0xffff
    buffer_load_dwordx4 v4, s[40:43], s63 offen nt lds
    buffer_load_dwordx4 v4, s[40:43], s63 offen offset:2048 nt lds
    s_add_u32 s63, s62, s60
    s_add_u32 m0, s61, 32768
    s_add_u32 s60, s60, 4096
    s_and_b32 s60, s60, 0xffff
    buffer_load_dwordx4 v4, s[40:43], s63 offen nt lds
    buffer_load_dwordx4 v4, s[40:43], s63 offen offset:2048 nt lds
L_xbspin:
    ds_read_b32 v15, v12 offset:0
    s_waitcnt lgkmcnt(0)
    v_readfirstlane_b32 s66, v15
    s_sub_u32 s67, s67, 1
    s_cbranch_scc1 L_xbspin_x
    s_cmp_lt_u32 s66, 8
    s_cbranch_scc1 L_xbspin
L_xbspin_x:
    s_add_u32 s63, s62, s60
    s_add_u32 m0, s61, 36864
    s_add_u32 s60, s60, 4096
    s_and_b32 s60, s60, 0xffff
    buffer_load_dwordx4 v4, s[40:43], s63 offen nt lds
    buffer_load_dwordx4 v4, s[40:43], s63 offen offset:2048 nt lds
    s_add_u32 s63, s62, s60
    s_add_u32 m0, s61, 40960
    s_add_u32 s60, s60, 4096
    s_and_b32 s60, s60, 0xffff
    buffer_load_dwordx4 v4, s[40:43], s63 offen nt lds
    buffer_load_dwordx4 v4, s[40:43], s63 offen offset:2048 nt lds
    s_add_u32 s63, s62, s60
    s_add_u32 m0, s61, 45056
    s_add_u32 s60, s60, 4096
    s_and_b32 s60, s60, 0xffff
    buffer_load_dwordx4 v4, s[40:43], s63 offen nt lds
    buffer_load_dwordx4 v4, s[40:43], s63 offen offset:2048 nt lds
    s_add_u32 s63, s62, s60
    s_add_u32 m0, s61, 49152
    s_add_u32 s60, s60, 4096
    s_and_b32 s60, s60, 0xffff
    buffer_load_dwordx4 v4, s[40:43], s63 offen nt lds
    buffer_load_dwordx4 v4, s[40:43], s63 offen offset:2048 nt lds
    s_add_u32 s63, s62, s60
    s_add_u32 m0, s61, 53248
    s_add_u32 s60, s60, 4096
    s_and_b32 s60, s60, 0xffff
    buffer_load_dwordx4 v4, s[40:43], s63 offen nt lds
    buffer_load_dwordx4 v4, s[40:43], s63 offen offset:2048 nt lds
L_k7spin:
    ds_read_b32 v15, v12 offset:20
    s_waitcnt lgkmcnt(0)
    v_readfirstlane_b32 s66, v15
    s_sub_u32 s67, s67, 1
    s_cbranch_scc1 L_k7spin_x
    s_cmp_lt_u32 s66, 1
    s_cbranch_scc1 L_k7spin
L_k7spin_x:
    s_add_u32 s63, s62, s60
    s_add_u32 m0, s61, 57344
    s_add_u32 s60, s60, 4096
    s_and_b32 s60, s60, 0xffff
    buffer_load_dwordx4 v4, s[40:43], s63 offen nt lds
    buffer_load_dwordx4 v4, s[40:43], s63 offen offset:2048 nt lds
    s_add_u32 s63, s62, s60
    s_add_u32 m0, s61, 61440
    s_add_u32 s60, s60, 4096
    s_and_b32 s60, s60, 0xffff
    buffer_load_dwordx4 v4, s[40:43], s63 offen nt lds
    buffer_load_dwordx4 v4, s[40:43], s63 offen offset:2048 nt lds
    s_mov_b32 exec_lo, 1
    s_mov_b32 exec_hi, 0
    ds_add_u32 v12, v13 offset:28
    s_mov_b64 exec, -1
    s_mov_b32 exec_lo, 1
    s_mov_b32 exec_hi, 0
    s_waitcnt vmcnt(16)
    ds_write_b32 v11, v8
    s_waitcnt vmcnt(8)
    ds_write_b32 v11, v9
    s_waitcnt vmcnt(4)
    ds_write_b32 v11, v7
    s_mov_b64 exec, -1
    s_waitcnt vmcnt(0)
    s_barrier
    s_branch L_final
L_w0:
    s_setprio 3
    s_lshl_b32 s61, s52, 8
    s_waitcnt lgkmcnt(0)
    s_add_u32 s61, s61, 160512
    v_add_u32 v6, s61, v6
    s_mov_b32 s44, s28
    s_and_b32 s45, s29, 0xffff
    s_mov_b32 s46, 0x20000000
    s_mov_b32 s47, 0x20000
    s_add_u32 s80, s28, 0xe0000
    s_addc_u32 s81, s29, 0
    s_and_b32 s81, s81, 0xffff
    s_mov_b32 s82, 0x1ff20000
    s_mov_b32 s83, 0x20000
    s_mov_b32 s74, 0
    s_mov_b32 s56, 0x1f058840
    s_load_dwordx2 s[56:57], s[28:29], s56
    s_mov_b32 s68, 0x3db504f3
    s_mov_b32 s69, 0x3fb8aa3b
    s_mov_b32 s70, 0xbfb8aa3b
    s_mov_b32 s92, 0x0c0c0400
    s_mov_b32 s93, 0x04000c0c
    s_mov_b32 s94, 0x07060500
    s_mov_b32 s95, 0x07060501
    s_mov_b32 s96, 0x07060502
    s_mov_b32 s97, 0x07060503
    v_bfe_u32 v12, v0, 3, 2
    v_xor_b32 v12, 0, v12
    v_lshlrev_b32 v12, 5, v12
    v_and_b32 v13, 3, v0
    v_lshl_add_u32 v12, v13, 3, v12
    v_lshrrev_b32 v13, 2, v0
    v_lshl_add_u32 v8, v13, 7, v12
    v_add_u32 v8, 65536, v8
    v_bfe_u32 v12, v0, 3, 2
    v_xor_b32 v12, 1, v12
    v_lshlrev_b32 v12, 5, v12
    v_and_b32 v13, 3, v0
    v_lshl_add_u32 v12, v13, 3, v12
    v_lshrrev_b32 v13, 2, v0
    v_lshl_add_u32 v9, v13, 7, v12
    v_add_u32 v9, 65536, v9
    v_bfe_u32 v12, v0, 3, 2
    v_xor_b32 v12, 2, v12
    v_lshlrev_b32 v12, 5, v12
    v_and_b32 v13, 3, v0
    v_lshl_add_u32 v12, v13, 3, v12
    v_lshrrev_b32 v13, 2, v0
    v_lshl_add_u32 v10, v13, 7, v12
    v_add_u32 v10, 65536, v10
    v_bfe_u32 v12, v0, 3, 2
    v_xor_b32 v12, 3, v12
    v_lshlrev_b32 v12, 5, v12
    v_and_b32 v13, 3, v0
    v_lshl_add_u32 v12, v13, 3, v12
    v_lshrrev_b32 v13, 2, v0
    v_lshl_add_u32 v11, v13, 7, v12
    v_add_u32 v11, 65536, v11
    v_lshlrev_b32 v12, 2, v0
    v_add_u32 v12, 159488, v12
    v_and_b32 v13, 31, v0
    v_lshlrev_b32 v13, 4, v13
    v_add_u32 v13, 159488, v13
    v_and_b32 v14, 1, v3
    v_lshlrev_b32 v14, 13, v14
    v_lshl_add_u32 v14, v2, 4, v14
    s_lshl_b32 s62, s31, 14
    s_lshl_b32 s63, s52, 11
    s_add_u32 s62, s62, s63
    s_lshl_b32 s63, s53, 8
    s_add_u32 s62, s62, s63
    s_add_u32 s62, s62, 0x1f000000
    s_waitcnt lgkmcnt(0)
    s_add_u32 s58, s56, 0x01010101
    s_add_u32 s59, s57, 0x9e3779b9
    s_and_b32 s88, s58, 0xffff
    s_and_b32 s89, s58, 0xffff0000
    v_mov_b32 v5, s58
    v_mov_b32 v4, 160272
L_wspin:
    ds_read_b32 v15, v4 offset:52
    s_waitcnt lgkmcnt(0)
    v_readfirstlane_b32 s66, v15
    s_sub_u32 s67, s67, 1
    s_cbranch_scc1 L_wspin_x
    s_cmp_lt_u32 s66, 4
    s_cbranch_scc1 L_wspin
L_wspin_x:
L_d4:
    ds_read2_b64 v[16:19], v6 offset0:0 offset1:4
    ds_read2_b64 v[20:23], v6 offset0:8 offset1:12
    ds_read2_b64 v[24:27], v6 offset0:16 offset1:20
    ds_read2_b64 v[28:31], v6 offset0:24 offset1:28
    ds_read_b64_tr_b16 v[32:33], v8 offset:0
    ds_read_b64_tr_b16 v[34:35], v8 offset:2048
    ds_read_b64_tr_b16 v[36:37], v8 offset:4096
    ds_read_b64_tr_b16 v[38:39], v8 offset:6144
    ds_read_b64_tr_b16 v[40:41], v8 offset:8192
    ds_read_b64_tr_b16 v[42:43], v8 offset:10240
    ds_read_b64_tr_b16 v[44:45], v8 offset:12288
    ds_read_b64_tr_b16 v[46:47], v8 offset:14336
    ds_read_b64_tr_b16 v[48:49], v9 offset:0
    ds_read_b64_tr_b16 v[50:51], v9 offset:2048
    s_waitcnt lgkmcnt(8)
    v_mfma_f32_16x16x32_bf16 v[96:99], v[16:19], v[32:35], 0
    ds_read_b64_tr_b16 v[52:53], v9 offset:4096
    ds_read_b64_tr_b16 v[54:55], v9 offset:6144
    s_waitcnt lgkmcnt(8)
    v_mfma_f32_16x16x32_bf16 v[96:99], v[20:23], v[36:39], v[96:99]
    ds_read_b64_tr_b16 v[56:57], v9 offset:8192
    ds_read_b64_tr_b16 v[58:59], v9 offset:10240
    s_waitcnt lgkmcnt(8)
    v_mfma_f32_16x16x32_bf16 v[96:99], v[24:27], v[40:43], v[96:99]
    ds_read_b64_tr_b16 v[60:61], v9 offset:12288
    ds_read_b64_tr_b16 v[62:63], v9 offset:14336
    s_waitcnt lgkmcnt(8)
    v_mfma_f32_16x16x32_bf16 v[96:99], v[28:31], v[44:47], v[96:99]
    ds_read_b64_tr_b16 v[64:65], v10 offset:0
    ds_read_b64_tr_b16 v[66:67], v10 offset:2048
    s_waitcnt lgkmcnt(8)
    v_mfma_f32_16x16x32_bf16 v[100:103], v[16:19], v[48:51], 0
    ds_read_b64_tr_b16 v[68:69], v10 offset:4096
    ds_read_b64_tr_b16 v[70:71], v10 offset:6144
    s_waitcnt lgkmcnt(8)
    v_mfma_f32_16x16x32_bf16 v[100:103], v[20:23], v[52:55], v[100:103]
    ds_read_b64_tr_b16 v[72:73], v10 offset:8192
    ds_read_b64_tr_b16 v[74:75], v10 offset:10240
    s_waitcnt lgkmcnt(8)
    v_mfma_f32_16x16x32_bf16 v[100:103], v[24:27], v[56:59], v[100:103]
    ds_read_b64_tr_b16 v[76:77], v10 offset:12288
    ds_read_b64_tr_b16 v[78:79], v10 offset:14336
    s_waitcnt lgkmcnt(8)
    v_mfma_f32_16x16x32_bf16 v[100:103], v[28:31], v[60:63], v[100:103]
    ds_read_b64_tr_b16 v[80:81], v11 offset:0
    ds_read_b64_tr_b16 v[82:83], v11 offset:2048
    s_waitcnt lgkmcnt(8)
    v_mfma_f32_16x16x32_bf16 v[104:107], v[16:19], v[64:67], 0
    ds_read_b64_tr_b16 v[84:85], v11 offset:4096
    ds_read_b64_tr_b16 v[86:87], v11 offset:6144
    s_waitcnt lgkmcnt(8)
    v_mfma_f32_16x16x32_bf16 v[104:107], v[20:23], v[68:71], v[104:107]
    ds_read_b64_tr_b16 v[88:89], v11 offset:8192
    ds_read_b64_tr_b16 v[90:91], v11 offset:10240
    s_waitcnt lgkmcnt(8)
    v_mfma_f32_16x16x32_bf16 v[104:107], v[24:27], v[72:75], v[104:107]
    ds_read_b64_tr_b16 v[92:93], v11 offset:12288
    ds_read_b64_tr_b16 v[94:95], v11 offset:14336
    s_waitcnt lgkmcnt(8)
    v_mfma_f32_16x16x32_bf16 v[104:107], v[28:31], v[76:79], v[104:107]
    s_waitcnt lgkmcnt(6)
    v_mfma_f32_16x16x32_bf16 v[108:111], v[16:19], v[80:83], 0
    s_waitcnt lgkmcnt(4)
    v_mfma_f32_16x16x32_bf16 v[108:111], v[20:23], v[84:87], v[108:111]
    s_waitcnt lgkmcnt(2)
    v_mfma_f32_16x16x32_bf16 v[108:111], v[24:27], v[88:91], v[108:111]
    s_waitcnt lgkmcnt(0)
    v_mfma_f32_16x16x32_bf16 v[108:111], v[28:31], v[92:95], v[108:111]
    s_nop 7
    s_nop 1
    v_permlane16_swap_b32 v96, v100
    v_permlane16_swap_b32 v104, v108
    v_permlane16_swap_b32 v97, v101
    v_permlane16_swap_b32 v105, v109
    s_nop 0
    v_permlane32_swap_b32 v96, v104
    v_permlane32_swap_b32 v97, v105
    s_nop 0
    ds_write_b32 v12, v96
    ds_write_b32 v12, v97 offset:256
    ds_read_b128 v[116:119], v13
    s_waitcnt lgkmcnt(0)
    v_perm_b32 v112, v116, v5, s94
    v_perm_b32 v113, v117, v5, s95
    v_perm_b32 v114, v118, v5, s96
    v_perm_b32 v115, v119, v5, s97
    s_mov_b32 exec_hi, 0
    buffer_store_dwordx4 v[112:115], v14, s[44:47], s62 offen
    buffer_store_dwordx4 v[112:115], v14, s[80:83], s62 offen sc1
    v_mov_b32 v12, 160272
    v_mov_b32 v8, 1
    ds_write_b32 v12, v8 offset:40
    s_setprio 0
    s_mov_b64 exec, -1
    s_mov_b32 s36, s12
    s_and_b32 s37, s13, 0xffff
    s_mov_b32 s38, 0x400000
    s_mov_b32 s39, 0x20000
    s_mov_b32 s40, s20
    s_and_b32 s41, s21, 0xffff
    s_mov_b32 s42, 0x1c0000
    s_mov_b32 s43, 0x20000
    v_bfe_u32 v8, v0, 1, 2
    v_bfe_u32 v9, v0, 4, 2
    v_xor_b32 v8, v8, v9
    v_and_b32 v9, 1, v0
    v_lshl_add_u32 v8, v8, 1, v9
    v_lshlrev_b32 v8, 4, v8
    v_lshrrev_b32 v9, 3, v0
    v_lshl_add_u32 v4, v9, 10, v8
    s_lshl_b32 s60, s54, 17
    s_lshl_b32 s63, s53, 7
    s_add_u32 s60, s60, s63
    s_lshl_b32 s61, s55, 16
    s_add_u32 s61, s61, s63
    v_mov_b32 v12, 160272
    v_mov_b32 v8, 1
    v_mov_b32 v9, 2
    v_mov_b32 v10, 3
L_ispin:
    ds_read_b32 v15, v12 offset:28
    s_waitcnt lgkmcnt(0)
    v_readfirstlane_b32 s66, v15
    s_sub_u32 s67, s67, 1
    s_cbranch_scc1 L_ispin_x
    s_cmp_lt_u32 s66, 3
    s_cbranch_scc1 L_ispin
L_ispin_x:
    s_cmp_eq_u32 s49, 0
    s_cbranch_scc1 L_w0_nowd
    s_mov_b32 m0, 81920
    s_nop 0
    buffer_load_dwordx4 v4, s[40:43], s61 offen nt lds
    s_mov_b32 m0, 82944
    s_add_u32 s61, s61, 8192
    buffer_load_dwordx4 v4, s[40:43], s61 offen nt lds
    s_mov_b32 m0, 83968
    s_add_u32 s61, s61, 8192
    buffer_load_dwordx4 v4, s[40:43], s61 offen nt lds
    s_mov_b32 m0, 84992
    s_add_u32 s61, s61, 8192
    buffer_load_dwordx4 v4, s[40:43], s61 offen nt lds
    s_mov_b32 m0, 86016
    s_add_u32 s61, s61, 8192
    buffer_load_dwordx4 v4, s[40:43], s61 offen nt lds
    s_mov_b32 m0, 87040
    s_add_u32 s61, s61, 8192
    buffer_load_dwordx4 v4, s[40:43], s61 offen nt lds
    s_mov_b32 m0, 88064
    s_add_u32 s61, s61, 8192
    buffer_load_dwordx4 v4, s[40:43], s61 offen nt lds
    s_mov_b32 m0, 89088
    s_add_u32 s61, s61, 8192
    buffer_load_dwordx4 v4, s[40:43], s61 offen nt lds
L_w0_nowd:
    s_mov_b32 m0, 65536
    s_nop 0
    buffer_load_dwordx4 v4, s[36:39], s60 offen nt lds
    s_mov_b32 m0, 66560
    s_add_u32 s60, s60, 8192
    buffer_load_dwordx4 v4, s[36:39], s60 offen nt lds
    s_mov_b32 m0, 67584
    s_add_u32 s60, s60, 8192
    buffer_load_dwordx4 v4, s[36:39], s60 offen nt lds
    s_mov_b32 m0, 68608
    s_add_u32 s60, s60, 8192
    buffer_load_dwordx4 v4, s[36:39], s60 offen nt lds
    s_mov_b32 m0, 69632
    s_add_u32 s60, s60, 8192
    buffer_load_dwordx4 v4, s[36:39], s60 offen nt lds
    s_mov_b32 m0, 70656
    s_add_u32 s60, s60, 8192
    buffer_load_dwordx4 v4, s[36:39], s60 offen nt lds
    s_mov_b32 m0, 71680
    s_add_u32 s60, s60, 8192
    buffer_load_dwordx4 v4, s[36:39], s60 offen nt lds
    s_mov_b32 m0, 72704
    s_add_u32 s60, s60, 8192
    buffer_load_dwordx4 v4, s[36:39], s60 offen nt lds
    s_mov_b32 m0, 73728
    s_add_u32 s60, s60, 8192
    buffer_load_dwordx4 v4, s[36:39], s60 offen nt lds
    s_mov_b32 m0, 74752
    s_add_u32 s60, s60, 8192
    buffer_load_dwordx4 v4, s[36:39], s60 offen nt lds
    s_mov_b32 m0, 75776
    s_add_u32 s60, s60, 8192
    buffer_load_dwordx4 v4, s[36:39], s60 offen nt lds
    s_mov_b32 m0, 76800
    s_add_u32 s60, s60, 8192
    buffer_load_dwordx4 v4, s[36:39], s60 offen nt lds
    s_mov_b32 m0, 77824
    s_add_u32 s60, s60, 8192
    buffer_load_dwordx4 v4, s[36:39], s60 offen nt lds
    s_mov_b32 m0, 78848
    s_add_u32 s60, s60, 8192
    buffer_load_dwordx4 v4, s[36:39], s60 offen nt lds
    s_mov_b32 m0, 79872
    s_add_u32 s60, s60, 8192
    buffer_load_dwordx4 v4, s[36:39], s60 offen nt lds
    s_mov_b32 m0, 80896
    s_add_u32 s60, s60, 8192
    buffer_load_dwordx4 v4, s[36:39], s60 offen nt lds
    s_barrier
    s_barrier
    s_waitcnt vmcnt(16)
    ds_write_b32 v12, v8 offset:12
    s_waitcnt vmcnt(8)
    ds_write_b32 v12, v9 offset:12
    s_waitcnt vmcnt(0)
    ds_write_b32 v12, v10 offset:12
    s_mov_b32 s75, 1
    s_branch L_final0
L_w1_idle:
    s_waitcnt lgkmcnt(0)
    s_mov_b32 s44, s28
    s_and_b32 s45, s29, 0xffff
    s_mov_b32 s46, 0x20000000
    s_mov_b32 s47, 0x20000
    s_add_u32 s80, s28, 0xe0000
    s_addc_u32 s81, s29, 0
    s_and_b32 s81, s81, 0xffff
    s_mov_b32 s82, 0x1ff20000
    s_mov_b32 s83, 0x20000
    s_mov_b32 s74, 0
    s_mov_b32 s56, 0x1f058840
    s_load_dwordx2 s[56:57], s[28:29], s56
    s_mov_b32 s68, 0x3db504f3
    s_mov_b32 s69, 0x3fb8aa3b
    s_mov_b32 s70, 0xbfb8aa3b
    s_mov_b32 s92, 0x0c0c0400
    s_mov_b32 s93, 0x04000c0c
    s_mov_b32 s94, 0x07060500
    s_mov_b32 s95, 0x07060501
    s_mov_b32 s96, 0x07060502
    s_mov_b32 s97, 0x07060503
    s_waitcnt lgkmcnt(0)
    s_add_u32 s58, s56, 0x01010101
    s_add_u32 s59, s57, 0x9e3779b9
    s_and_b32 s88, s58, 0xffff
    s_and_b32 s89, s58, 0xffff0000
    v_mov_b32 v11, 160272
    v_mov_b32 v14, 1
    s_mov_b32 exec_lo, 1
    s_mov_b32 exec_hi, 0
    ds_add_u32 v11, v14 offset:28
    s_mov_b64 exec, -1
    s_barrier
    s_branch L_final
L_w1:
    s_cmp_eq_u32 s49, 0
    s_cbranch_scc1 L_w1_idle
    s_lshl_b32 s61, s53, 7
    s_waitcnt lgkmcnt(0)
    s_add_u32 s61, s61, 160512
    v_add_u32 v6, s61, v6
    s_mov_b32 s44, s28
    s_and_b32 s45, s29, 0xffff
    s_mov_b32 s46, 0x20000000
    s_mov_b32 s47, 0x20000
    s_add_u32 s80, s28, 0xe0000
    s_addc_u32 s81, s29, 0
    s_and_b32 s81, s81, 0xffff
    s_mov_b32 s82, 0x1ff20000
    s_mov_b32 s83, 0x20000
    s_mov_b32 s74, 0
    s_mov_b32 s56, 0x1f058840
    s_load_dwordx2 s[56:57], s[28:29], s56
    s_mov_b32 s68, 0x3db504f3
    s_mov_b32 s69, 0x3fb8aa3b
    s_mov_b32 s70, 0xbfb8aa3b
    s_mov_b32 s92, 0x0c0c0400
    s_mov_b32 s93, 0x04000c0c
    s_mov_b32 s94, 0x07060500
    s_mov_b32 s95, 0x07060501
    s_mov_b32 s96, 0x07060502
    s_mov_b32 s97, 0x07060503
    v_bfe_u32 v12, v0, 3, 2
    v_xor_b32 v12, 0, v12
    v_lshlrev_b32 v12, 5, v12
    v_and_b32 v13, 3, v0
    v_lshl_add_u32 v12, v13, 3, v12
    v_lshrrev_b32 v13, 2, v0
    v_lshl_add_u32 v8, v13, 7, v12
    v_add_u32 v8, 81920, v8
    v_bfe_u32 v12, v0, 3, 2
    v_xor_b32 v12, 1, v12
    v_lshlrev_b32 v12, 5, v12
    v_and_b32 v13, 3, v0
    v_lshl_add_u32 v12, v13, 3, v12
    v_lshrrev_b32 v13, 2, v0
    v_lshl_add_u32 v9, v13, 7, v12
    v_add_u32 v9, 81920, v9
    v_bfe_u32 v12, v0, 3, 2
    v_xor_b32 v12, 2, v12
    v_lshlrev_b32 v12, 5, v12
    v_and_b32 v13, 3, v0
    v_lshl_add_u32 v12, v13, 3, v12
    v_lshrrev_b32 v13, 2, v0
    v_lshl_add_u32 v10, v13, 7, v12
    v_add_u32 v10, 81920, v10
    v_bfe_u32 v12, v0, 3, 2
    v_xor_b32 v12, 3, v12
    v_lshlrev_b32 v12, 5, v12
    v_and_b32 v13, 3, v0
    v_lshl_add_u32 v12, v13, 3, v12
    v_lshrrev_b32 v13, 2, v0
    v_lshl_add_u32 v11, v13, 7, v12
    v_add_u32 v11, 81920, v11
    v_lshlrev_b32 v5, 4, v0
    s_lshl_b32 s62, s55, 13
    s_add_u32 s62, s62, 0x1f020000
    s_lshl_b32 s63, s53, 10
    s_add_u32 s63, s63, s62
    s_add_u32 s61, s62, 4096
    v_lshlrev_b32 v12, 1, v0
    v_add_u32 v12, 159232, v12
    v_mov_b32 v13, 160288
    v_mov_b32 v14, 1
    s_waitcnt lgkmcnt(0)
    s_add_u32 s58, s56, 0x01010101
    s_add_u32 s59, s57, 0x9e3779b9
    s_and_b32 s88, s58, 0xffff
    s_and_b32 s89, s58, 0xffff0000
    v_mov_b32 v4, s58
    v_mov_b32 v7, 160272
L_gspin:
    ds_read_b32 v15, v7 offset:56
    s_waitcnt lgkmcnt(0)
    v_readfirstlane_b32 s66, v15
    s_sub_u32 s67, s67, 1
    s_cbranch_scc1 L_gspin_x
    s_cmp_lt_u32 s66, 4
    s_cbranch_scc1 L_gspin
L_gspin_x:
L_d5:
    ds_read2_b64 v[16:19], v6 offset0:0 offset1:4
    ds_read2_b64 v[20:23], v6 offset0:8 offset1:12
    ds_read_b64_tr_b16 v[24:25], v8 offset:0
    ds_read_b64_tr_b16 v[26:27], v8 offset:2048
    ds_read_b64_tr_b16 v[28:29], v8 offset:4096
    ds_read_b64_tr_b16 v[30:31], v8 offset:6144
    ds_read_b64_tr_b16 v[32:33], v9 offset:0
    ds_read_b64_tr_b16 v[34:35], v9 offset:2048
    ds_read_b64_tr_b16 v[36:37], v9 offset:4096
    ds_read_b64_tr_b16 v[38:39], v9 offset:6144
    ds_read_b64_tr_b16 v[40:41], v10 offset:0
    ds_read_b64_tr_b16 v[42:43], v10 offset:2048
    s_waitcnt lgkmcnt(8)
    v_mfma_f32_16x16x32_bf16 v[88:91], v[16:19], v[24:27], 0
    ds_read_b64_tr_b16 v[44:45], v10 offset:4096
    ds_read_b64_tr_b16 v[46:47], v10 offset:6144
    s_waitcnt lgkmcnt(8)
    v_mfma_f32_16x16x32_bf16 v[88:91], v[20:23], v[28:31], v[88:91]
    ds_read_b64_tr_b16 v[48:49], v11 offset:0
    ds_read_b64_tr_b16 v[50:51], v11 offset:2048
    s_waitcnt lgkmcnt(8)
    v_mfma_f32_16x16x32_bf16 v[92:95], v[16:19], v[32:35], 0
    ds_read_b64_tr_b16 v[52:53], v11 offset:4096
    ds_read_b64_tr_b16 v[54:55], v11 offset:6144
    s_waitcnt lgkmcnt(8)
    v_mfma_f32_16x16x32_bf16 v[92:95], v[20:23], v[36:39], v[92:95]
    ds_read_b64_tr_b16 v[56:57], v8 offset:8192
    ds_read_b64_tr_b16 v[58:59], v8 offset:10240
    s_waitcnt lgkmcnt(8)
    v_mfma_f32_16x16x32_bf16 v[96:99], v[16:19], v[40:43], 0
    ds_read_b64_tr_b16 v[60:61], v8 offset:12288
    ds_read_b64_tr_b16 v[62:63], v8 offset:14336
    s_waitcnt lgkmcnt(8)
    v_mfma_f32_16x16x32_bf16 v[96:99], v[20:23], v[44:47], v[96:99]
    ds_read_b64_tr_b16 v[64:65], v9 offset:8192
    ds_read_b64_tr_b16 v[66:67], v9 offset:10240
    s_waitcnt lgkmcnt(8)
    v_mfma_f32_16x16x32_bf16 v[100:103], v[16:19], v[48:51], 0
    ds_read_b64_tr_b16 v[68:69], v9 offset:12288
    ds_read_b64_tr_b16 v[70:71], v9 offset:14336
    s_waitcnt lgkmcnt(8)
    v_mfma_f32_16x16x32_bf16 v[100:103], v[20:23], v[52:55], v[100:103]
    ds_read_b64_tr_b16 v[72:73], v10 offset:8192
    ds_read_b64_tr_b16 v[74:75], v10 offset:10240
    s_waitcnt lgkmcnt(8)
    v_mfma_f32_16x16x32_bf16 v[104:107], v[16:19], v[56:59], 0
    ds_read_b64_tr_b16 v[76:77], v10 offset:12288
    ds_read_b64_tr_b16 v[78:79], v10 offset:14336
    s_waitcnt lgkmcnt(8)
    v_mfma_f32_16x16x32_bf16 v[104:107], v[20:23], v[60:63], v[104:107]
    ds_read_b64_tr_b16 v[80:81], v11 offset:8192
    ds_read_b64_tr_b16 v[82:83], v11 offset:10240
    s_waitcnt lgkmcnt(8)
    v_mfma_f32_16x16x32_bf16 v[108:111], v[16:19], v[64:67], 0
    ds_read_b64_tr_b16 v[84:85], v11 offset:12288
    ds_read_b64_tr_b16 v[86:87], v11 offset:14336
    s_waitcnt lgkmcnt(8)
    v_mfma_f32_16x16x32_bf16 v[108:111], v[20:23], v[68:71], v[108:111]
    s_waitcnt lgkmcnt(6)
    v_mfma_f32_16x16x32_bf16 v[112:115], v[16:19], v[72:75], 0
    s_waitcnt lgkmcnt(4)
    v_mfma_f32_16x16x32_bf16 v[112:115], v[20:23], v[76:79], v[112:115]
    s_waitcnt lgkmcnt(2)
    v_mfma_f32_16x16x32_bf16 v[116:119], v[16:19], v[80:83], 0
    s_waitcnt lgkmcnt(0)
    v_mfma_f32_16x16x32_bf16 v[116:119], v[20:23], v[84:87], v[116:119]
    s_nop 7
    s_nop 1
    v_permlane16_swap_b32 v88, v92
    v_permlane16_swap_b32 v96, v100
    v_permlane16_swap_b32 v89, v93
    v_permlane16_swap_b32 v97, v101
    v_permlane16_swap_b32 v104, v108
    v_permlane16_swap_b32 v112, v116
    v_permlane16_swap_b32 v105, v109
    v_permlane16_swap_b32 v113, v117
    s_nop 0
    v_permlane32_swap_b32 v88, v96
    v_permlane32_swap_b32 v89, v97
    v_permlane32_swap_b32 v104, v112
    v_permlane32_swap_b32 v105, v113
    s_nop 0
    v_perm_b32 v120, v88, v4, s94
    v_perm_b32 v121, v89, v4, s95
    v_perm_b32 v122, v104, v4, s96
    v_perm_b32 v123, v105, v4, s97
    buffer_store_dwordx4 v[120:123], v5, s[44:47], s63 offen
    buffer_store_dwordx4 v[120:123], v5, s[80:83], s63 offen sc1
    v_mov_b32 v11, 160272
    s_mov_b32 exec_lo, 1
    s_mov_b32 exec_hi, 0
    ds_add_u32 v11, v14 offset:28
    s_mov_b64 exec, -1
L_hw:
    ds_read_b32 v15, v11 offset:24
    s_waitcnt lgkmcnt(0)
    v_readfirstlane_b32 s66, v15
    s_sub_u32 s67, s67, 1
    s_cbranch_scc1 L_hw_x
    s_cmp_lt_u32 s66, 2
    s_cbranch_scc1 L_hw
L_hw_x:
    buffer_load_dwordx4 v[16:19], v5, s[44:47], s62 offen offset:0 sc1
    buffer_load_dwordx4 v[20:23], v5, s[44:47], s62 offen offset:1024 sc1
    buffer_load_dwordx4 v[24:27], v5, s[44:47], s62 offen offset:2048 sc1
    buffer_load_dwordx4 v[28:31], v5, s[44:47], s62 offen offset:3072 sc1
    buffer_load_dwordx4 v[32:35], v5, s[44:47], s61 offen offset:0 sc1
    buffer_load_dwordx4 v[36:39], v5, s[44:47], s61 offen offset:1024 sc1
    buffer_load_dwordx4 v[40:43], v5, s[44:47], s61 offen offset:2048 sc1
    buffer_load_dwordx4 v[44:47], v5, s[44:47], s61 offen offset:3072 sc1
L_d3:
    s_waitcnt vmcnt(0)
L_hchk:
    v_perm_b32 v97, v17, v16, s92
    v_perm_b32 v98, v19, v18, s93
    v_xor_b32 v97, s88, v97
    v_xor_b32 v98, s89, v98
    v_or_b32 v96, v97, v98
    v_perm_b32 v97, v21, v20, s92
    v_perm_b32 v98, v23, v22, s93
    v_xor_b32 v97, s88, v97
    v_xor_b32 v98, s89, v98
    v_or3_b32 v96, v96, v97, v98
    v_perm_b32 v97, v25, v24, s92
    v_perm_b32 v98, v27, v26, s93
    v_xor_b32 v97, s88, v97
    v_xor_b32 v98, s89, v98
    v_or3_b32 v96, v96, v97, v98
    v_perm_b32 v97, v29, v28, s92
    v_perm_b32 v98, v31, v30, s93
    v_xor_b32 v97, s88, v97
    v_xor_b32 v98, s89, v98
    v_or3_b32 v96, v96, v97, v98
    v_perm_b32 v97, v33, v32, s92
    v_perm_b32 v98, v35, v34, s93
    v_xor_b32 v97, s88, v97
    v_xor_b32 v98, s89, v98
    v_or3_b32 v96, v96, v97, v98
    v_perm_b32 v97, v37, v36, s92
    v_perm_b32 v98, v39, v38, s93
    v_xor_b32 v97, s88, v97
    v_xor_b32 v98, s89, v98
    v_or3_b32 v96, v96, v97, v98
    v_perm_b32 v97, v41, v40, s92
    v_perm_b32 v98, v43, v42, s93
    v_xor_b32 v97, s88, v97
    v_xor_b32 v98, s89, v98
    v_or3_b32 v96, v96, v97, v98
    v_perm_b32 v97, v45, v44, s92
    v_perm_b32 v98, v47, v46, s93
    v_xor_b32 v97, s88, v97
    v_xor_b32 v98, s89, v98
    v_or3_b32 v96, v96, v97, v98
    s_nop 1
    v_or_b32_dpp v96, v96, v96 quad_perm:[1,0,3,2] row_mask:0xf bank_mask:0xf
    s_nop 1
    v_or_b32_dpp v96, v96, v96 quad_perm:[2,3,0,1] row_mask:0xf bank_mask:0xf
    v_cmp_ne_u32 vcc, 0, v96
    s_nop 1
    s_cbranch_vccz L_hchk_ok
    s_sub_u32 s67, s67, 1
    s_cbranch_scc1 L_hchk_ok
    s_mov_b64 exec, vcc
    s_add_u32 s74, s74, 1
    s_and_b32 s75, s74, 7
    s_cbranch_scc0 L_hchk_b
    buffer_load_dwordx4 v[16:19], v5, s[44:47], s62 offen offset:0 sc1
    buffer_load_dwordx4 v[20:23], v5, s[44:47], s62 offen offset:1024 sc1
    buffer_load_dwordx4 v[24:27], v5, s[44:47], s62 offen offset:2048 sc1
    buffer_load_dwordx4 v[28:31], v5, s[44:47], s62 offen offset:3072 sc1
    buffer_load_dwordx4 v[32:35], v5, s[44:47], s61 offen offset:0 sc1
    buffer_load_dwordx4 v[36:39], v5, s[44:47], s61 offen offset:1024 sc1
    buffer_load_dwordx4 v[40:43], v5, s[44:47], s61 offen offset:2048 sc1
    buffer_load_dwordx4 v[44:47], v5, s[44:47], s61 offen offset:3072 sc1
    s_waitcnt vmcnt(0)
    s_branch L_hchk
L_hchk_b:
    buffer_load_dwordx4 v[16:19], v5, s[80:83], s62 offen offset:0 sc1
    buffer_load_dwordx4 v[20:23], v5, s[80:83], s62 offen offset:1024 sc1
    buffer_load_dwordx4 v[24:27], v5, s[80:83], s62 offen offset:2048 sc1
    buffer_load_dwordx4 v[28:31], v5, s[80:83], s62 offen offset:3072 sc1
    buffer_load_dwordx4 v[32:35], v5, s[80:83], s61 offen offset:0 sc1
    buffer_load_dwordx4 v[36:39], v5, s[80:83], s61 offen offset:1024 sc1
    buffer_load_dwordx4 v[40:43], v5, s[80:83], s61 offen offset:2048 sc1
    buffer_load_dwordx4 v[44:47], v5, s[80:83], s61 offen offset:3072 sc1
    s_waitcnt vmcnt(0)
    s_branch L_hchk
L_hchk_ok:
    s_mov_b64 exec, -1
    v_and_b32 v16, 0xffffff00, v16
    v_and_b32 v17, 0xffffff00, v17
    v_and_b32 v18, 0xffffff00, v18
    v_and_b32 v19, 0xffffff00, v19
    v_and_b32 v20, 0xffffff00, v20
    v_and_b32 v21, 0xffffff00, v21
    v_and_b32 v22, 0xffffff00, v22
    v_and_b32 v23, 0xffffff00, v23
    v_and_b32 v24, 0xffffff00, v24
    v_and_b32 v25, 0xffffff00, v25
    v_and_b32 v26, 0xffffff00, v26
    v_and_b32 v27, 0xffffff00, v27
    v_and_b32 v28, 0xffffff00, v28
    v_and_b32 v29, 0xffffff00, v29
    v_and_b32 v30, 0xffffff00, v30
    v_and_b32 v31, 0xffffff00, v31
    v_and_b32 v32, 0xffffff00, v32
    v_and_b32 v33, 0xffffff00, v33
    v_and_b32 v34, 0xffffff00, v34
    v_and_b32 v35, 0xffffff00, v35
    v_and_b32 v36, 0xffffff00, v36
    v_and_b32 v37, 0xffffff00, v37
    v_and_b32 v38, 0xffffff00, v38
    v_and_b32 v39, 0xffffff00, v39
    v_and_b32 v40, 0xffffff00, v40
    v_and_b32 v41, 0xffffff00, v41
    v_and_b32 v42, 0xffffff00, v42
    v_and_b32 v43, 0xffffff00, v43
    v_and_b32 v44, 0xffffff00, v44
    v_and_b32 v45, 0xffffff00, v45
    v_and_b32 v46, 0xffffff00, v46
    v_and_b32 v47, 0xffffff00, v47
    v_add_f32 v16, v16, v32
    v_add_f32 v17, v17, v33
    v_add_f32 v18, v18, v34
    v_add_f32 v19, v19, v35
    v_add_f32 v20, v20, v36
    v_add_f32 v21, v21, v37
    v_add_f32 v22, v22, v38
    v_add_f32 v23, v23, v39
    v_add_f32 v24, v24, v40
    v_add_f32 v25, v25, v41
    v_add_f32 v26, v26, v42
    v_add_f32 v27, v27, v43
    v_add_f32 v28, v28, v44
    v_add_f32 v29, v29, v45
    v_add_f32 v30, v30, v46
    v_add_f32 v31, v31, v47
    v_add_f32 v16, v16, v24
    v_add_f32 v17, v17, v25
    v_add_f32 v18, v18, v26
    v_add_f32 v19, v19, v27
    v_add_f32 v20, v20, v28
    v_add_f32 v21, v21, v29
    v_add_f32 v22, v22, v30
    v_add_f32 v23, v23, v31
    v_add_f32 v16, v16, v20
    v_add_f32 v17, v17, v21
    v_add_f32 v18, v18, v22
    v_add_f32 v19, v19, v23
    v_cvt_pk_bf16_f32 v24, v16, v17
    v_cvt_pk_bf16_f32 v25, v18, v19
    v_lshlrev_b32 v16, 16, v24
    v_and_b32 v17, 0xffff0000, v24
    v_lshlrev_b32 v18, 16, v25
    v_and_b32 v19, 0xffff0000, v25
    v_mul_f32 v24, s70, v16
    v_mul_f32 v25, s70, v17
    v_exp_f32 v24, v24
    v_exp_f32 v25, v25
    s_nop 0
    v_add_f32 v24, 1.0, v24
    v_add_f32 v25, 1.0, v25
    v_rcp_f32 v24, v24
    v_rcp_f32 v25, v25
    s_nop 0
    v_mul_f32 v16, v16, v24
    v_mul_f32 v17, v17, v25
    v_cvt_pk_bf16_f32 v24, v16, v17
    v_lshlrev_b32 v16, 16, v24
    v_and_b32 v17, 0xffff0000, v24
    v_mul_f32 v16, v16, v18
    v_mul_f32 v17, v17, v19
    v_cvt_pk_bf16_f32 v24, v16, v17
    ds_write_b16 v12, v24
    ds_write_b16_d16_hi v12, v24 offset:128
    ds_write_b32 v13, v14
    s_barrier
L_final:
    s_mov_b32 s75, 0
L_final0:
    v_bfe_u32 v12, v0, 3, 2
    v_xor_b32 v12, s30, v12
    v_lshlrev_b32 v12, 5, v12
    v_and_b32 v13, 3, v0
    v_lshl_add_u32 v12, v13, 3, v12
    v_lshrrev_b32 v13, 2, v0
    v_lshl_add_u32 v8, v13, 7, v12
    v_add_u32 v8, 65536, v8
    v_mov_b32 v12, 160272
    v_and_b32 v9, 1, v2
    v_lshlrev_b32 v10, 7, v9
    v_lshl_add_u32 v10, v3, 3, v10
    v_add_u32 v10, 159232, v10
    v_lshlrev_b32 v9, 8, v9
    v_lshl_add_u32 v9, v3, 3, v9
    v_add_u32 v9, 158720, v9
    v_lshrrev_b32 v11, 2, v2
    v_lshlrev_b32 v11, 11, v11
    v_and_b32 v13, 3, v2
    v_lshl_add_u32 v11, v13, 4, v11
    s_lshl_b32 s60, s53, 15
    s_lshl_b32 s61, s30, 13
    s_add_u32 s60, s60, s61
    s_lshl_b32 s61, s54, 6
    s_add_u32 s60, s60, s61
    s_add_u32 s60, s60, 0x1f0e0000
    v_and_b32 v7, 31, v0
    v_mul_u32_u24 v7, 2176, v7
    s_mul_i32 s61, s31, 69632
    s_lshl_b32 s62, s52, 4
    s_add_u32 s61, s61, s62
    s_add_u32 s61, s61, 0x1f058800
    v_mov_b32 v13, 160256
    ds_read_b128 v[60:63], v13
    v_mov_b32 v65, s58
    v_mov_b32 v67, s59
    v_mov_b32 v56, 0
    v_mov_b32 v57, 0
    s_cmp_eq_u32 s75, 1
    s_cbranch_scc1 L_nobp
    s_barrier
L_nobp:
    buffer_load_dwordx4 v[68:71], v7, s[44:47], s61 offen sc1
    s_cmp_eq_u32 s49, 0
    s_cbranch_scc1 L_f_nofb
L_fs1:
    ds_read_b32 v15, v12 offset:12
    s_waitcnt lgkmcnt(0)
    v_readfirstlane_b32 s66, v15
    s_sub_u32 s67, s67, 1
    s_cbranch_scc1 L_fs1_x
    s_cmp_lt_u32 s66, 1
    s_cbranch_scc1 L_fs1
L_fs1_x:
    ds_read_b64_tr_b16 v[16:17], v8 offset:16384
    ds_read_b64_tr_b16 v[18:19], v8 offset:18432
    ds_read_b64_tr_b16 v[20:21], v8 offset:20480
    ds_read_b64_tr_b16 v[22:23], v8 offset:22528
L_fs2:
    ds_read_b32 v15, v12 offset:16
    s_waitcnt lgkmcnt(0)
    v_readfirstlane_b32 s66, v15
    s_sub_u32 s67, s67, 1
    s_cbranch_scc1 L_fs2_x
    s_cmp_lt_u32 s66, 1
    s_cbranch_scc1 L_fs2
L_fs2_x:
    ds_read2_b64 v[24:27], v10 offset0:0 offset1:4
    ds_read2_b64 v[28:31], v10 offset0:8 offset1:12
    s_waitcnt lgkmcnt(0)
    v_mfma_f32_16x16x32_bf16 v[56:59], v[24:27], v[16:19], 0
    v_mfma_f32_16x16x32_bf16 v[56:59], v[28:31], v[20:23], v[56:59]
    s_nop 7
    s_nop 1
    v_mul_f32 v56, v56, v62
    v_mul_f32 v57, v57, v63
L_f_nofb:
L_fs3:
    ds_read_b32 v15, v12 offset:12
    s_waitcnt lgkmcnt(0)
    v_readfirstlane_b32 s66, v15
    s_sub_u32 s67, s67, 1
    s_cbranch_scc1 L_fs3_x
    s_cmp_lt_u32 s66, 3
    s_cbranch_scc1 L_fs3
L_fs3_x:
    ds_read_b64_tr_b16 v[16:17], v8 offset:0
    ds_read_b64_tr_b16 v[18:19], v8 offset:2048
    ds_read_b64_tr_b16 v[20:21], v8 offset:4096
    ds_read_b64_tr_b16 v[22:23], v8 offset:6144
    ds_read_b64_tr_b16 v[24:25], v8 offset:8192
    ds_read_b64_tr_b16 v[26:27], v8 offset:10240
    ds_read_b64_tr_b16 v[28:29], v8 offset:12288
    ds_read_b64_tr_b16 v[30:31], v8 offset:14336
    s_waitcnt vmcnt(0)
L_lchk:
    v_xor_b32 v73, s58, v69
    v_xor_b32 v74, s59, v71
    v_or_b32 v72, v73, v74
    v_cmp_ne_u32 vcc, 0, v72
    s_nop 1
    s_cbranch_vccz L_lchk_ok
    s_sub_u32 s67, s67, 1
    s_cbranch_scc1 L_lchk_ok
    s_mov_b64 exec, vcc
    s_add_u32 s74, s74, 1
    s_and_b32 s75, s74, 7
    s_cbranch_scc0 L_lchk_b
    buffer_load_dwordx4 v[68:71], v7, s[44:47], s61 offen sc1
    s_waitcnt vmcnt(0)
    s_branch L_lchk
L_lchk_b:
    buffer_load_dwordx4 v[68:71], v7, s[80:83], s61 offen sc1
    s_waitcnt vmcnt(0)
    s_branch L_lchk
L_lchk_ok:
    s_mov_b64 exec, -1
    v_mov_b32 v72, v70
    v_mov_b32 v73, v70
    s_nop 1
    v_max_f32_dpp v73, v73, v73 row_ror:8 row_mask:0xf bank_mask:0xf
    s_nop 1
    v_max_f32_dpp v73, v73, v73 row_ror:4 row_mask:0xf bank_mask:0xf
    s_nop 1
    v_max_f32_dpp v73, v73, v73 row_ror:2 row_mask:0xf bank_mask:0xf
    s_nop 1
    v_max_f32_dpp v73, v73, v73 row_ror:1 row_mask:0xf bank_mask:0xf
    v_sub_f32 v72, v72, v73
    v_mul_f32 v72, s69, v72
    v_exp_f32 v72, v72
    s_nop 0
    v_mul_f32 v72, v72, v68
    s_nop 1
    v_add_f32_dpp v72, v72, v72 row_ror:8 row_mask:0xf bank_mask:0xf
    s_nop 1
    v_add_f32_dpp v72, v72, v72 row_ror:4 row_mask:0xf bank_mask:0xf
    s_nop 1
    v_add_f32_dpp v72, v72, v72 row_ror:2 row_mask:0xf bank_mask:0xf
    s_nop 1
    v_add_f32_dpp v72, v72, v72 row_ror:1 row_mask:0xf bank_mask:0xf
    v_rcp_f32 v72, v72
    s_nop 1
    v_readlane_b32 s62, v72, 0
    v_readlane_b32 s63, v72, 16
    s_nop 1
    v_mul_f32 v60, s62, v60
    v_mul_f32 v61, s63, v61
    s_barrier
    ds_read2_b64 v[32:35], v9 offset0:0 offset1:4
    ds_read2_b64 v[36:39], v9 offset0:8 offset1:12
    ds_read2_b64 v[40:43], v9 offset0:16 offset1:20
    ds_read2_b64 v[44:47], v9 offset0:24 offset1:28
    s_waitcnt lgkmcnt(3)
    v_mfma_f32_16x16x32_bf16 v[48:51], v[32:35], v[16:19], 0
    s_waitcnt lgkmcnt(2)
    v_mfma_f32_16x16x32_bf16 v[48:51], v[36:39], v[20:23], v[48:51]
    s_waitcnt lgkmcnt(1)
    v_mfma_f32_16x16x32_bf16 v[48:51], v[40:43], v[24:27], v[48:51]
    s_waitcnt lgkmcnt(0)
    v_mfma_f32_16x16x32_bf16 v[48:51], v[44:47], v[28:31], v[48:51]
    s_mov_b32 exec_lo, 0xffff
    s_mov_b32 exec_hi, 0x0
    s_nop 6
    v_fma_f32 v64, v48, v60, v56
    v_fma_f32 v66, v49, v61, v57
    buffer_store_dwordx4 v[64:67], v11, s[80:83], s60 offen sc1
L_end:
    s_endpgm
.section .rodata,"a"
.p2align 6
.amdhsa_kernel gated_mix__sliding_block_cached__swiglu_ffn__decode_kernel
  .amdhsa_next_free_vgpr 160
  .amdhsa_next_free_sgpr 102
  .amdhsa_accum_offset 160
  .amdhsa_group_segment_fixed_size 0
  .amdhsa_kernarg_size 104
  .amdhsa_user_sgpr_count 2
  .amdhsa_user_sgpr_kernarg_segment_ptr 1
  .amdhsa_system_sgpr_workgroup_id_x 1
.end_amdhsa_kernel
```
